```python
import torch

def _softmax(x, axis=-1):
    return torch.softmax(x, dim=axis)

def _gelu(x):
    return torch.nn.functional.gelu(x, approximate='tanh')

def _silu(x):
    return torch.nn.functional.silu(x)

def _sigmoid(x):
    return torch.sigmoid(x)

def _layernorm(x, axis=-1, eps=1e-05):
    m = x.mean(dim=axis, keepdim=True)
    v = x.var(dim=axis, keepdim=True, unbiased=False)
    return (x - m) / torch.sqrt(v + eps)

def _scatter_add(tgt, idx, src, axis=0):
    return tgt.clone().index_add_(axis, idx, src)

def _segment_sum(src, seg, n):
    out = torch.zeros((n,) + src.shape[1:], dtype=src.dtype)
    return out.index_add_(0, seg, src)

def _pad(x, pw):
    flat = tuple((v for pair in reversed(pw) for v in pair))
    return torch.nn.functional.pad(x, flat)
kernel_name = 'gather_scatter__molecular_angular_painn__graph'

def setup_inputs():

    _w = lambda a: (lambda t: t.to(torch.bfloat16) if t.is_floating_point() else t)(torch.as_tensor(a))
    N, deg, D = (10000, 64, 64)
    n_rbf = max(16, 4)
    E = N * deg
    cutoff = 5.0
    freqs = (torch.arange(1, n_rbf + 1) * torch.pi / cutoff).to(float)
    return {'sv': _w((lambda *s: torch.randn(*s, dtype=torch.bfloat16) * 0.4)(N, 4, D) * 0.3), 'pos': _w((lambda *s: torch.randn(*s, dtype=torch.bfloat16) * 1.6)(N, 3) * 1.2), 'src': _w((lambda lo, hi, *s: torch.randint(lo, hi, s))(0, N, E).to(torch.int64)), 'dst': _w((lambda lo, hi, *s: torch.randint(lo, hi, s))(0, N, E).to(torch.int64)), 'freqs': _w(freqs), 'w_phi1': _w((lambda *s: torch.randn(*s, dtype=torch.bfloat16) * 3.2)(D, D) / D ** 0.5), 'w_phi2': _w((lambda *s: torch.randn(*s, dtype=torch.bfloat16) * 1.6)(D, 3 * D) / D ** 0.5), 'w_rbf': _w((lambda *s: torch.randn(*s, dtype=torch.bfloat16) * 1.6)(n_rbf, 3 * D) / n_rbf ** 0.5)}

def reference(sv, pos, src, dst, freqs, w_phi1, w_phi2, w_rbf):
    N, _, D = sv.shape
    E = src.shape[0]
    PI, cutoff = (3.141592653589793, 5.0)
    s, v = (sv[:, 0, :].clone(), sv[:, 1:, :].clone())
    r_vec = pos[src] - pos[dst]
    d = torch.sqrt((r_vec * r_vec).sum(-1) + 1e-08)
    r_hat = r_vec / d[:, None]
    rbf = torch.sin(d[:, None] * freqs[None, :]) / d[:, None]
    fcut = 0.5 * (torch.cos(PI * d / cutoff) + 1.0)
    fcut = torch.where(d < cutoff, fcut, 0.0 * d)
    Wf = rbf @ w_rbf * fcut[:, None]
    phi = (_silu(s @ w_phi1) @ w_phi2)[src]
    m = phi * Wf
    m_s, m_vv, m_vr = (m[:, :D].clone(), m[:, D:2 * D].clone(), m[:, 2 * D:].clone())
    ds = _segment_sum(m_s, dst, N)
    dv_e = m_vv[:, None, :] * v[src] + m_vr[:, None, :] * r_hat[:, :, None]
    dv = _segment_sum(dv_e.reshape(E, 3 * D), dst, N).reshape(N, 3, D)
    return sv + torch.concatenate([ds[:, None, :], dv], axis=1)
```

```asm
; @launch kernel=painn_prep_kernel grid=(256,1,1) block=(1024,1,1) lds=161792
; @launch kernel=painn_msg_kernel grid=(256,1,1) block=(512,1,1) lds=162816
.amdgcn_target "amdgcn-amd-amdhsa--gfx950"
.text
.globl painn_prep_kernel
.p2align 8
.type painn_prep_kernel,@function
painn_prep_kernel:
    s_cmp_ge_u32 s2, 256
    s_cbranch_scc1 K1_END
    s_load_dwordx16 s[16:31], s[0:1], 0
    s_load_dwordx2 s[32:33], s[0:1], 80
    v_lshrrev_b32 v1, 6, v0
    v_and_b32 v2, 63, v0
    v_readfirstlane_b32 s3, v1
    s_cmp_ge_u32 s2, 160
    s_cbranch_scc1 K1_MLP
    v_lshlrev_b32 v3, 4, v0
    v_lshlrev_b32 v4, 4, v2
    v_mul_u32_u24 v6, 12, v0
    s_mul_i32 s4, s2, 16000
    s_waitcnt lgkmcnt(0)
    s_mov_b32 s44, s18
    s_and_b32 s45, s19, 0xffff
    s_mov_b32 s46, 60000
    s_mov_b32 s47, 0x00020000
    s_mov_b32 s36, s20
    s_and_b32 s37, s21, 0xffff
    s_mov_b32 s38, 2560000
    s_mov_b32 s39, 0x00020000
    s_mov_b32 s40, s22
    s_and_b32 s41, s23, 0xffff
    s_mov_b32 s42, 2560000
    s_mov_b32 s43, 0x00020000
    s_mov_b32 s60, 0
    s_mul_i32 s6, s60, 12288
    buffer_load_dwordx3 v[72:74], v6, s[44:47], s6 offen
    s_add_u32 s61, s60, 1
    s_cmp_eq_u32 s61, 5
    s_cselect_b32 s61, 0, s61
    s_mul_i32 s6, s61, 12288
    buffer_load_dwordx3 v[76:78], v6, s[44:47], s6 offen
    s_add_u32 s62, s61, 1
    s_cmp_eq_u32 s62, 5
    s_cselect_b32 s62, 0, s62
    s_mul_i32 s6, s62, 12288
    buffer_load_dwordx3 v[80:82], v6, s[44:47], s6 offen
    s_add_u32 s63, s62, 1
    s_cmp_eq_u32 s63, 5
    s_cselect_b32 s63, 0, s63
    s_mul_i32 s6, s63, 12288
    buffer_load_dwordx3 v[84:86], v6, s[44:47], s6 offen
    s_add_u32 s64, s63, 1
    s_cmp_eq_u32 s64, 5
    s_cselect_b32 s64, 0, s64
    s_mul_i32 s6, s64, 12288
    buffer_load_dwordx3 v[88:90], v6, s[44:47], s6 offen
    s_barrier
    buffer_load_dwordx4 v[8:11], v3, s[36:39], s4 offen
    buffer_load_dwordx4 v[12:15], v3, s[40:43], s4 offen
    s_mov_b32 s48, s32
    s_and_b32 s49, s33, 0xffff
    s_mov_b32 s50, 18874368
    s_mov_b32 s51, 0x00020000
    v_mov_b32 v5, 0
    v_lshrrev_b32 v7, 2, v3
    v_and_b32 v7, 0x3ff, v7
    v_add_u32 v16, 81920, v4
    v_add_u32 v7, 81920, v7
    ds_write_b32 v7, v5
    s_mov_b32 s7, 10066
    s_movk_i32 s9, 1000
    v_cmp_gt_u32 s[10:11], s9, v0
    v_mov_b32 v5, 1
    v_lshl_add_u32 v102, s60, 14, v3
    v_lshl_add_u32 v103, s61, 14, v3
    v_lshl_add_u32 v104, s62, 14, v3
    v_lshl_add_u32 v105, s63, 14, v3
    v_lshl_add_u32 v106, s64, 14, v3
    s_waitcnt vmcnt(6)
    v_and_b32 v75, 0xffff0000, v74
    v_alignbit_b32 v74, v74, v73, 16
    v_lshlrev_b32 v73, 16, v73
    ds_write_b128 v102, v[72:75]
    s_waitcnt vmcnt(5)
    v_and_b32 v79, 0xffff0000, v78
    v_alignbit_b32 v78, v78, v77, 16
    v_lshlrev_b32 v77, 16, v77
    ds_write_b128 v103, v[76:79]
    s_waitcnt vmcnt(4)
    v_and_b32 v83, 0xffff0000, v82
    v_alignbit_b32 v82, v82, v81, 16
    v_lshlrev_b32 v81, 16, v81
    ds_write_b128 v104, v[80:83]
    s_waitcnt vmcnt(3)
    v_and_b32 v87, 0xffff0000, v86
    v_alignbit_b32 v86, v86, v85, 16
    v_lshlrev_b32 v85, 16, v85
    ds_write_b128 v105, v[84:87]
    s_waitcnt vmcnt(2)
    v_and_b32 v91, 0xffff0000, v90
    v_alignbit_b32 v90, v90, v89, 16
    v_lshlrev_b32 v89, 16, v89
    ds_write_b128 v106, v[88:91]
    s_waitcnt lgkmcnt(0)
    s_barrier
    s_waitcnt vmcnt(0)
    v_lshlrev_b32 v92, 3, v8
    v_lshlrev_b32 v93, 3, v12
    v_lshlrev_b32 v94, 3, v9
    v_lshlrev_b32 v95, 3, v13
    v_lshlrev_b32 v96, 3, v10
    v_lshlrev_b32 v97, 3, v14
    v_lshlrev_b32 v98, 3, v11
    v_lshlrev_b32 v99, 3, v15
    ds_read_b64 v[20:21], v92
    ds_read_b64 v[22:23], v93
    ds_read_b64 v[24:25], v94
    ds_read_b64 v[26:27], v95
    ds_read_b64 v[28:29], v96
    ds_read_b64 v[30:31], v97
    ds_read_b64 v[32:33], v98
    ds_read_b64 v[34:35], v99
    v_mul_u32_u24 v56, s7, v8
    v_lshrrev_b32 v60, 8, v12
    v_lshrrev_b32 v56, 24, v56
    v_mad_u32_u24 v56, v56, 40, v60
    v_lshrrev_b32 v60, 1, v93
    v_and_b32 v60, 0x3fc, v60
    v_add_u32 v60, 81920, v60
    v_mul_u32_u24 v57, s7, v9
    v_lshrrev_b32 v61, 8, v13
    v_lshrrev_b32 v57, 24, v57
    v_mad_u32_u24 v57, v57, 40, v61
    v_lshrrev_b32 v61, 1, v95
    v_and_b32 v61, 0x3fc, v61
    v_add_u32 v61, 81920, v61
    v_mul_u32_u24 v58, s7, v10
    v_lshrrev_b32 v62, 8, v14
    v_lshrrev_b32 v58, 24, v58
    v_mad_u32_u24 v58, v58, 40, v62
    v_lshrrev_b32 v62, 1, v97
    v_and_b32 v62, 0x3fc, v62
    v_add_u32 v62, 81920, v62
    v_mul_u32_u24 v59, s7, v11
    v_lshrrev_b32 v63, 8, v15
    v_lshrrev_b32 v59, 24, v59
    v_mad_u32_u24 v59, v59, 40, v63
    v_lshrrev_b32 v63, 1, v99
    v_and_b32 v63, 0x3fc, v63
    v_add_u32 v63, 81920, v63
    s_waitcnt lgkmcnt(6)
    v_lshlrev_b32 v66, 16, v20
    v_lshlrev_b32 v70, 16, v22
    v_and_b32 v20, 0xffff0000, v20
    v_and_b32 v22, 0xffff0000, v22
    v_sub_f32 v66, v66, v70
    v_sub_f32 v67, v20, v22
    v_sub_f32 v68, v21, v23
    v_cvt_pk_bf16_f32 v66, 0, v66
    v_cvt_pk_bf16_f32 v67, 0, v67
    v_cvt_pk_bf16_f32 v68, 0, v68
    v_mul_f32 v69, v66, v66
    v_mul_f32 v70, v67, v67
    v_mul_f32 v71, v68, v68
    v_cvt_pk_bf16_f32 v69, 0, v69
    v_cvt_pk_bf16_f32 v70, 0, v70
    v_cvt_pk_bf16_f32 v71, 0, v71
    v_add_f32 v69, v69, v70
    v_add_f32 v69, v69, v71
    v_cvt_pk_bf16_f32 v69, 0, v69
    v_add_f32 v69, 0x322bcc77, v69
    v_cvt_pk_bf16_f32 v69, 0, v69
    v_sqrt_f32 v69, v69
    s_nop 0
    v_cvt_pk_bf16_f32 v69, 0, v69
    v_rcp_f32 v70, v69
    v_lshrrev_b32 v69, 16, v69
    v_mul_f32 v66, v66, v70
    v_mul_f32 v67, v67, v70
    v_mul_f32 v68, v68, v70
    v_cmp_gt_u32 vcc, 16541, v69
    v_subrev_u32 v69, 14544, v69
    v_cvt_pk_bf16_f32 v66, 0, v66
    v_cvt_pk_bf16_f32 v67, 0, v67
    v_cvt_pk_bf16_f32 v68, 0, v68
    v_or_b32 v40, v66, v69
    v_lshl_or_b32 v41, v56, 2, v67
    v_or_b32 v42, v68, v8
    s_and_b64 s[52:53], vcc, s[10:11]
    s_mov_b64 exec, s[52:53]
    ds_add_rtn_u32 v43, v60, v5
    s_mov_b64 exec, -1
    s_waitcnt lgkmcnt(4)
    v_lshlrev_b32 v66, 16, v24
    v_lshlrev_b32 v70, 16, v26
    v_and_b32 v24, 0xffff0000, v24
    v_and_b32 v26, 0xffff0000, v26
    v_sub_f32 v66, v66, v70
    v_sub_f32 v67, v24, v26
    v_sub_f32 v68, v25, v27
    v_cvt_pk_bf16_f32 v66, 0, v66
    v_cvt_pk_bf16_f32 v67, 0, v67
    v_cvt_pk_bf16_f32 v68, 0, v68
    v_mul_f32 v69, v66, v66
    v_mul_f32 v70, v67, v67
    v_mul_f32 v71, v68, v68
    v_cvt_pk_bf16_f32 v69, 0, v69
    v_cvt_pk_bf16_f32 v70, 0, v70
    v_cvt_pk_bf16_f32 v71, 0, v71
    v_add_f32 v69, v69, v70
    v_add_f32 v69, v69, v71
    v_cvt_pk_bf16_f32 v69, 0, v69
    v_add_f32 v69, 0x322bcc77, v69
    v_cvt_pk_bf16_f32 v69, 0, v69
    v_sqrt_f32 v69, v69
    s_nop 0
    v_cvt_pk_bf16_f32 v69, 0, v69
    v_rcp_f32 v70, v69
    v_lshrrev_b32 v69, 16, v69
    v_mul_f32 v66, v66, v70
    v_mul_f32 v67, v67, v70
    v_mul_f32 v68, v68, v70
    v_cmp_gt_u32 vcc, 16541, v69
    v_subrev_u32 v69, 14544, v69
    v_cvt_pk_bf16_f32 v66, 0, v66
    v_cvt_pk_bf16_f32 v67, 0, v67
    v_cvt_pk_bf16_f32 v68, 0, v68
    v_or_b32 v44, v66, v69
    v_lshl_or_b32 v45, v57, 2, v67
    v_or_b32 v46, v68, v9
    s_and_b64 s[54:55], vcc, s[10:11]
    s_mov_b64 exec, s[54:55]
    ds_add_rtn_u32 v47, v61, v5
    s_mov_b64 exec, -1
    s_waitcnt lgkmcnt(2)
    v_lshlrev_b32 v66, 16, v28
    v_lshlrev_b32 v70, 16, v30
    v_and_b32 v28, 0xffff0000, v28
    v_and_b32 v30, 0xffff0000, v30
    v_sub_f32 v66, v66, v70
    v_sub_f32 v67, v28, v30
    v_sub_f32 v68, v29, v31
    v_cvt_pk_bf16_f32 v66, 0, v66
    v_cvt_pk_bf16_f32 v67, 0, v67
    v_cvt_pk_bf16_f32 v68, 0, v68
    v_mul_f32 v69, v66, v66
    v_mul_f32 v70, v67, v67
    v_mul_f32 v71, v68, v68
    v_cvt_pk_bf16_f32 v69, 0, v69
    v_cvt_pk_bf16_f32 v70, 0, v70
    v_cvt_pk_bf16_f32 v71, 0, v71
    v_add_f32 v69, v69, v70
    v_add_f32 v69, v69, v71
    v_cvt_pk_bf16_f32 v69, 0, v69
    v_add_f32 v69, 0x322bcc77, v69
    v_cvt_pk_bf16_f32 v69, 0, v69
    v_sqrt_f32 v69, v69
    s_nop 0
    v_cvt_pk_bf16_f32 v69, 0, v69
    v_rcp_f32 v70, v69
    v_lshrrev_b32 v69, 16, v69
    v_mul_f32 v66, v66, v70
    v_mul_f32 v67, v67, v70
    v_mul_f32 v68, v68, v70
    v_cmp_gt_u32 vcc, 16541, v69
    v_subrev_u32 v69, 14544, v69
    v_cvt_pk_bf16_f32 v66, 0, v66
    v_cvt_pk_bf16_f32 v67, 0, v67
    v_cvt_pk_bf16_f32 v68, 0, v68
    v_or_b32 v48, v66, v69
    v_lshl_or_b32 v49, v58, 2, v67
    v_or_b32 v50, v68, v10
    s_and_b64 s[56:57], vcc, s[10:11]
    s_mov_b64 exec, s[56:57]
    ds_add_rtn_u32 v51, v62, v5
    s_mov_b64 exec, -1
    s_waitcnt lgkmcnt(0)
    v_lshlrev_b32 v66, 16, v32
    v_lshlrev_b32 v70, 16, v34
    v_and_b32 v32, 0xffff0000, v32
    v_and_b32 v34, 0xffff0000, v34
    v_sub_f32 v66, v66, v70
    v_sub_f32 v67, v32, v34
    v_sub_f32 v68, v33, v35
    v_cvt_pk_bf16_f32 v66, 0, v66
    v_cvt_pk_bf16_f32 v67, 0, v67
    v_cvt_pk_bf16_f32 v68, 0, v68
    v_mul_f32 v69, v66, v66
    v_mul_f32 v70, v67, v67
    v_mul_f32 v71, v68, v68
    v_cvt_pk_bf16_f32 v69, 0, v69
    v_cvt_pk_bf16_f32 v70, 0, v70
    v_cvt_pk_bf16_f32 v71, 0, v71
    v_add_f32 v69, v69, v70
    v_add_f32 v69, v69, v71
    v_cvt_pk_bf16_f32 v69, 0, v69
    v_add_f32 v69, 0x322bcc77, v69
    v_cvt_pk_bf16_f32 v69, 0, v69
    v_sqrt_f32 v69, v69
    s_nop 0
    v_cvt_pk_bf16_f32 v69, 0, v69
    v_rcp_f32 v70, v69
    v_lshrrev_b32 v69, 16, v69
    v_mul_f32 v66, v66, v70
    v_mul_f32 v67, v67, v70
    v_mul_f32 v68, v68, v70
    v_cmp_gt_u32 vcc, 16541, v69
    v_subrev_u32 v69, 14544, v69
    v_cvt_pk_bf16_f32 v66, 0, v66
    v_cvt_pk_bf16_f32 v67, 0, v67
    v_cvt_pk_bf16_f32 v68, 0, v68
    v_or_b32 v52, v66, v69
    v_lshl_or_b32 v53, v59, 2, v67
    v_or_b32 v54, v68, v11
    s_and_b64 s[58:59], vcc, s[10:11]
    s_mov_b64 exec, s[58:59]
    ds_add_rtn_u32 v55, v63, v5
    s_mov_b64 exec, -1
    s_lshl_b32 s5, s3, 10
    s_lshl_b32 s6, s2, 2
    s_add_u32 s5, s5, s6
    s_add_u32 s5, s5, 16777216
    v_lshlrev_b32 v30, 12, v2
    s_waitcnt lgkmcnt(0)
    s_barrier
    ds_read_b128 v[20:23], v16
    s_waitcnt lgkmcnt(0)
    v_add_u32 v25, v20, v21
    v_add_u32 v26, v25, v22
    v_add_u32 v27, v26, v23
    v_mov_b32 v28, v27
    s_nop 1
    v_add_u32_dpp v28, v28, v28 row_shr:1 row_mask:0xf bank_mask:0xf bound_ctrl:0
    s_nop 1
    v_add_u32_dpp v28, v28, v28 row_shr:2 row_mask:0xf bank_mask:0xf bound_ctrl:0
    s_nop 1
    v_add_u32_dpp v28, v28, v28 row_shr:4 row_mask:0xf bank_mask:0xf bound_ctrl:0
    s_nop 1
    v_add_u32_dpp v28, v28, v28 row_shr:8 row_mask:0xf bank_mask:0xf bound_ctrl:0
    s_nop 1
    v_add_u32_dpp v28, v28, v28 row_bcast:15 row_mask:0xa bank_mask:0xf
    s_nop 1
    v_add_u32_dpp v28, v28, v28 row_bcast:31 row_mask:0xc bank_mask:0xf
    v_sub_u32 v24, v28, v27
    v_add_u32 v27, v24, v26
    v_add_u32 v26, v24, v25
    v_add_u32 v25, v24, v20
    ds_write_b128 v16, v[24:27] offset:1024
    ds_read_b32 v32, v60 offset:1024
    ds_read_b32 v33, v61 offset:1024
    ds_read_b32 v34, v62 offset:1024
    ds_read_b32 v35, v63 offset:1024
    v_readlane_b32 s12, v28, 63
    s_cmp_ge_u32 s3, 4
    s_cbranch_scc1 K1_P_NOO
    v_lshl_or_b32 v29, v20, 16, v24
    s_cmp_eq_u32 s3, 1
    s_cbranch_scc0 K1_P_O1
    v_lshl_or_b32 v29, v21, 16, v25
K1_P_O1:
    s_cmp_eq_u32 s3, 2
    s_cbranch_scc0 K1_P_O2
    v_lshl_or_b32 v29, v22, 16, v26
K1_P_O2:
    s_cmp_eq_u32 s3, 3
    s_cbranch_scc0 K1_P_O3
    v_lshl_or_b32 v29, v23, 16, v27
K1_P_O3:
    buffer_store_dword v29, v30, s[48:51], s5 offen
K1_P_NOO:
    s_mul_i32 s5, s2, 49152
    s_add_u32 s5, s5, 8388608
    s_mul_i32 s12, s12, 12
    s_lshl_b32 s13, s3, 10
    s_waitcnt lgkmcnt(0)
    v_add_u32 v32, v32, v43
    v_mul_u32_u24 v32, 12, v32
    s_mov_b64 exec, s[52:53]
    ds_write2_b32 v32, v40, v41 offset1:1
    ds_write_b32 v32, v42 offset:8
    s_mov_b64 exec, -1
    v_add_u32 v33, v33, v47
    v_mul_u32_u24 v33, 12, v33
    s_mov_b64 exec, s[54:55]
    ds_write2_b32 v33, v44, v45 offset1:1
    ds_write_b32 v33, v46 offset:8
    s_mov_b64 exec, -1
    v_add_u32 v34, v34, v51
    v_mul_u32_u24 v34, 12, v34
    s_mov_b64 exec, s[56:57]
    ds_write2_b32 v34, v48, v49 offset1:1
    ds_write_b32 v34, v50 offset:8
    s_mov_b64 exec, -1
    v_add_u32 v35, v35, v55
    v_mul_u32_u24 v35, 12, v35
    s_mov_b64 exec, s[58:59]
    ds_write2_b32 v35, v52, v53 offset1:1
    ds_write_b32 v35, v54 offset:8
    s_mov_b64 exec, -1
    s_waitcnt lgkmcnt(0)
    s_barrier
    ds_read_b128 v[20:23], v3 offset:0
    ds_read_b128 v[24:27], v3 offset:16384
    ds_read_b128 v[28:31], v3 offset:32768
    s_cmp_ge_u32 s13, s12
    s_cbranch_scc1 K1_P_CPE
    s_waitcnt lgkmcnt(2)
    buffer_store_dwordx4 v[20:23], v3, s[48:51], s5 offen sc1
    s_add_u32 s13, s13, 16384
    s_add_u32 s5, s5, 16384
    s_cmp_ge_u32 s13, s12
    s_cbranch_scc1 K1_P_CPE
    s_waitcnt lgkmcnt(1)
    buffer_store_dwordx4 v[24:27], v3, s[48:51], s5 offen sc1
    s_add_u32 s13, s13, 16384
    s_add_u32 s5, s5, 16384
    s_cmp_ge_u32 s13, s12
    s_cbranch_scc1 K1_P_CPE
    s_waitcnt lgkmcnt(0)
    buffer_store_dwordx4 v[28:31], v3, s[48:51], s5 offen sc1
    s_add_u32 s13, s13, 16384
    s_add_u32 s5, s5, 16384
K1_P_CPE:
    s_endpgm
K1_MLP:
    s_cmp_ge_u32 s2, 250
    s_cbranch_scc1 K1_TAB
    s_sub_u32 s4, s2, 160
    v_lshrrev_b32 v5, 3, v2
    v_and_b32 v6, 7, v2
    v_xor_b32 v6, v6, v5
    v_lshlrev_b32 v5, 9, v5
    v_lshl_add_u32 v11, v6, 4, v5
    s_mul_i32 s15, s4, 57344
    s_lshl_b32 s14, s3, 12
    s_add_u32 s15, s15, s14
    s_lshl_b32 s9, s3, 10
    s_add_u32 s10, s9, 32768
    v_lshrrev_b32 v5, 5, v2
    v_bfe_u32 v6, v2, 3, 2
    v_bfe_u32 v7, v2, 1, 2
    v_and_b32 v8, 1, v2
    s_waitcnt lgkmcnt(0)
    s_mov_b32 s36, s16
    s_and_b32 s37, s17, 0xffff
    s_mov_b32 s38, 5120000
    s_mov_b32 s39, 0x00020000
    s_mov_b32 m0, s10
    s_cmp_ge_u32 s3, 14
    s_cbranch_scc1 K1_M_NOS
    buffer_load_dwordx4 v11, s[36:39], s15 offen lds
K1_M_NOS:
    s_mov_b32 s40, s26
    s_and_b32 s41, s27, 0xffff
    s_mov_b32 s42, 8192
    s_mov_b32 s43, 0x00020000
    s_mov_b32 s44, s28
    s_and_b32 s45, s29, 0xffff
    s_mov_b32 s46, 24576
    s_mov_b32 s47, 0x00020000
    v_lshl_add_u32 v9, v6, 1, v5
    v_lshl_add_u32 v9, v9, 2, v7
    v_lshlrev_b32 v9, 7, v9
    v_lshl_add_u32 v9, v8, 4, v9
    v_lshl_add_u32 v10, v5, 2, v6
    v_lshl_add_u32 v10, v10, 2, v7
    v_mul_u32_u24 v10, 384, v10
    v_lshl_add_u32 v10, v8, 4, v10
    s_and_b32 s5, s3, 1
    s_lshr_b32 s6, s3, 1
    s_lshl_b32 s12, s6, 5
    s_lshl_b32 s7, s5, 12
    s_add_u32 s7, s7, s12
    s_mul_i32 s8, s5, 12288
    s_add_u32 s8, s8, s12
    s_mov_b32 m0, s9
    s_cmp_ge_u32 s3, 8
    s_cbranch_scc1 K1_M_D2
    buffer_load_dwordx4 v9, s[40:43], s7 offen lds
    s_branch K1_M_D3
K1_M_D2:
    s_sub_u32 s7, s8, 128
    buffer_load_dwordx4 v10, s[44:47], s7 offen lds
K1_M_D3:
    s_add_u32 s9, s9, 16384
    s_mov_b32 m0, s9
    s_add_u32 s8, s8, 128
    buffer_load_dwordx4 v10, s[44:47], s8 offen lds
    s_barrier
    s_cmp_ge_u32 s3, 14
    s_cbranch_scc1 K1_M_IDLE
    v_mov_b32 v31, v11
    s_add_u32 s10, s10, 14336
    s_mov_b32 m0, s10
    s_add_u32 s15, s15, 128
    buffer_load_dwordx4 v31, s[36:39], s15 offen lds
    s_add_u32 s10, s10, 14336
    s_mov_b32 m0, s10
    s_add_u32 s15, s15, 128
    buffer_load_dwordx4 v31, s[36:39], s15 offen lds
    s_add_u32 s10, s10, 14336
    s_mov_b32 m0, s10
    s_add_u32 s15, s15, 128
    buffer_load_dwordx4 v31, s[36:39], s15 offen lds
    v_lshrrev_b32 v3, 4, v2
    v_and_b32 v4, 15, v2
    s_mul_i32 s13, s4, 112
    s_lshl_b32 s14, s6, 4
    s_add_u32 s13, s13, s14
    v_add_u32 v6, s14, v4
    v_lshlrev_b32 v6, 7, v6
    v_and_b32 v7, 7, v4
    v_xor_b32 v8, v7, v3
    v_lshl_add_u32 v36, v8, 4, v6
    v_xor_b32 v37, 64, v36
    v_lshrrev_b32 v8, 1, v3
    v_lshl_add_u32 v8, s5, 2, v8
    v_xor_b32 v8, v8, v7
    v_lshl_add_u32 v38, v8, 4, v6
    v_and_b32 v8, 1, v3
    v_lshl_add_u32 v38, v8, 3, v38
    v_add_u32 v38, 32768, v38
    v_xor_b32 v39, 32, v38
    s_mov_b32 s48, s32
    s_and_b32 s49, s33, 0xffff
    s_mov_b32 s50, 5120000
    s_mov_b32 s51, 0x00020000
    s_add_u32 s52, s32, 6291456
    s_addc_u32 s53, s33, 0
    s_mov_b32 s52, s52
    s_and_b32 s53, s53, 0xffff
    s_mov_b32 s54, 1280000
    s_mov_b32 s55, 0x00020000
    v_lshlrev_b32 v32, 3, v2
    s_lshl_b32 s9, s5, 12
    v_add_u32 v33, s9, v32
    s_lshl_b32 s12, s3, 12
    s_add_u32 s12, s12, 104448
    v_lshlrev_b32 v8, 1, v3
    v_xor_b32 v8, v8, v7
    v_lshl_add_u32 v8, v4, 4, v8
    v_lshl_add_u32 v9, v8, 4, s12
    v_xor_b32 v10, 16, v9
    v_xor_b32 v8, v4, v3
    v_lshl_add_u32 v8, v3, 4, v8
    v_lshl_add_u32 v11, v8, 4, s12
    v_xor_b32 v1, 64, v11
    v_lshlrev_b32 v34, 9, v3
    v_lshl_add_u32 v34, v4, 4, v34
    s_lshl_b32 s11, s13, 9
    s_lshl_b32 s12, s5, 8
    s_add_u32 s11, s11, s12
    s_add_u32 s12, s11, 4096
    v_lshrrev_b32 v8, 3, v2
    v_xor_b32 v8, v8, v2
    v_and_b32 v8, 7, v8
    v_and_b32 v35, 0x38, v2
    v_or_b32 v8, v8, v35
    s_lshl_b32 s14, s3, 10
    s_add_u32 s14, s14, 32768
    v_lshl_add_u32 v5, v8, 4, s14
    v_lshlrev_b32 v35, 4, v2
    s_mul_i32 s7, s4, 14336
    s_lshl_b32 s14, s3, 10
    s_add_u32 s7, s7, s14
    s_waitcnt vmcnt(3)
    s_barrier
    ds_read_b128 v[12:15], v36 offset:32768
    ds_read_b128 v[16:19], v37 offset:32768
    ds_read_b64_tr_b16 v[40:41], v33 offset:0
    ds_read_b64_tr_b16 v[42:43], v33 offset:512
    ds_read_b64_tr_b16 v[48:49], v33 offset:2048
    ds_read_b64_tr_b16 v[50:51], v33 offset:2560
    ds_read_b64_tr_b16 v[44:45], v33 offset:1024
    ds_read_b64_tr_b16 v[46:47], v33 offset:1536
    ds_read_b64_tr_b16 v[52:53], v33 offset:3072
    ds_read_b64_tr_b16 v[54:55], v33 offset:3584
    s_lshl_b32 s8, s3, 12
    s_add_u32 s8, s8, 104448
    v_add_u32 v30, s8, v35
    s_lshl_b32 s8, s6, 13
    s_add_u32 s8, s8, 104448
    v_add_u32 v29, s8, v35
    s_waitcnt lgkmcnt(4)
    v_mfma_f32_16x16x32_bf16 v[104:107], v[40:43], v[12:15], 0
    v_mfma_f32_16x16x32_bf16 v[108:111], v[48:51], v[12:15], 0
    s_waitcnt lgkmcnt(0)
    v_mfma_f32_16x16x32_bf16 v[104:107], v[44:47], v[16:19], v[104:107]
    v_mfma_f32_16x16x32_bf16 v[108:111], v[52:55], v[16:19], v[108:111]
    ds_read_b64_tr_b16 v[88:89], v33 offset:16384
    ds_read_b64_tr_b16 v[90:91], v33 offset:16896
    ds_read_b64_tr_b16 v[92:93], v33 offset:17408
    ds_read_b64_tr_b16 v[94:95], v33 offset:17920
    ds_read_b64_tr_b16 v[96:97], v33 offset:18432
    ds_read_b64_tr_b16 v[98:99], v33 offset:18944
    ds_read_b64_tr_b16 v[100:101], v33 offset:19456
    ds_read_b64_tr_b16 v[102:103], v33 offset:19968
    ds_read_b64_tr_b16 v[72:73], v33 offset:8192
    ds_read_b64_tr_b16 v[74:75], v33 offset:8704
    ds_read_b64_tr_b16 v[76:77], v33 offset:9216
    ds_read_b64_tr_b16 v[78:79], v33 offset:9728
    ds_read_b64_tr_b16 v[80:81], v33 offset:10240
    ds_read_b64_tr_b16 v[82:83], v33 offset:10752
    ds_read_b64_tr_b16 v[84:85], v33 offset:11264
    ds_read_b64_tr_b16 v[86:87], v33 offset:11776
    v_cvt_pk_bf16_f32 v104, 0, v104
    v_cvt_pk_bf16_f32 v105, 0, v105
    v_cvt_pk_bf16_f32 v106, 0, v106
    v_cvt_pk_bf16_f32 v107, 0, v107
    v_cvt_pk_bf16_f32 v108, 0, v108
    v_cvt_pk_bf16_f32 v109, 0, v109
    v_cvt_pk_bf16_f32 v110, 0, v110
    v_cvt_pk_bf16_f32 v111, 0, v111
    v_mul_f32 v56, 0xbfb8aa3b, v104
    v_mul_f32 v57, 0xbfb8aa3b, v105
    v_mul_f32 v58, 0xbfb8aa3b, v106
    v_mul_f32 v59, 0xbfb8aa3b, v107
    v_mul_f32 v60, 0xbfb8aa3b, v108
    v_mul_f32 v61, 0xbfb8aa3b, v109
    v_mul_f32 v62, 0xbfb8aa3b, v110
    v_mul_f32 v63, 0xbfb8aa3b, v111
    v_exp_f32 v56, v56
    v_exp_f32 v57, v57
    v_exp_f32 v58, v58
    v_exp_f32 v59, v59
    v_exp_f32 v60, v60
    v_exp_f32 v61, v61
    v_exp_f32 v62, v62
    v_exp_f32 v63, v63
    v_add_f32 v56, 1.0, v56
    v_add_f32 v57, 1.0, v57
    v_add_f32 v58, 1.0, v58
    v_add_f32 v59, 1.0, v59
    v_add_f32 v60, 1.0, v60
    v_add_f32 v61, 1.0, v61
    v_add_f32 v62, 1.0, v62
    v_add_f32 v63, 1.0, v63
    v_rcp_f32 v56, v56
    v_rcp_f32 v57, v57
    v_rcp_f32 v58, v58
    v_rcp_f32 v59, v59
    v_rcp_f32 v60, v60
    v_rcp_f32 v61, v61
    v_rcp_f32 v62, v62
    v_rcp_f32 v63, v63
    v_mul_f32 v56, v56, v104
    v_mul_f32 v57, v57, v105
    v_mul_f32 v58, v58, v106
    v_mul_f32 v59, v59, v107
    v_mul_f32 v60, v60, v108
    v_mul_f32 v61, v61, v109
    v_mul_f32 v62, v62, v110
    v_mul_f32 v63, v63, v111
    v_cvt_pk_bf16_f32 v64, v56, v57
    v_cvt_pk_bf16_f32 v65, v58, v59
    v_cvt_pk_bf16_f32 v66, v60, v61
    v_cvt_pk_bf16_f32 v67, v62, v63
    ds_write_b128 v30, v[64:67]
    ds_read_b64_tr_b16 v[40:41], v33 offset:24576
    ds_read_b64_tr_b16 v[42:43], v33 offset:25088
    ds_read_b64_tr_b16 v[44:45], v33 offset:25600
    ds_read_b64_tr_b16 v[46:47], v33 offset:26112
    ds_read_b64_tr_b16 v[48:49], v33 offset:26624
    ds_read_b64_tr_b16 v[50:51], v33 offset:27136
    ds_read_b64_tr_b16 v[52:53], v33 offset:27648
    ds_read_b64_tr_b16 v[54:55], v33 offset:28160
    s_waitcnt lgkmcnt(8)
    s_barrier
    ds_read_b128 v[12:15], v29
    ds_read_b128 v[16:19], v29 offset:4096
    s_waitcnt lgkmcnt(0)
    v_mfma_f32_16x16x32_bf16 v[104:107], v[72:75], v[12:15], 0
    v_mfma_f32_16x16x32_bf16 v[108:111], v[80:83], v[12:15], 0
    v_mfma_f32_16x16x32_bf16 v[120:123], v[40:43], v[12:15], 0
    v_mfma_f32_16x16x32_bf16 v[124:127], v[48:51], v[12:15], 0
    v_mfma_f32_16x16x32_bf16 v[112:115], v[88:91], v[12:15], 0
    v_mfma_f32_16x16x32_bf16 v[116:119], v[96:99], v[12:15], 0
    v_mfma_f32_16x16x32_bf16 v[104:107], v[76:79], v[16:19], v[104:107]
    v_mfma_f32_16x16x32_bf16 v[108:111], v[84:87], v[16:19], v[108:111]
    v_mfma_f32_16x16x32_bf16 v[120:123], v[44:47], v[16:19], v[120:123]
    v_mfma_f32_16x16x32_bf16 v[124:127], v[52:55], v[16:19], v[124:127]
    v_mfma_f32_16x16x32_bf16 v[112:115], v[92:95], v[16:19], v[112:115]
    v_mfma_f32_16x16x32_bf16 v[116:119], v[100:103], v[16:19], v[116:119]
    s_mov_b32 s8, 0x07060302
    s_nop 1
    v_cvt_pk_bf16_f32 v58, v104, v105
    v_lshlrev_b32 v104, 1, v58
    v_and_b32 v105, 0x7fff0000, v58
    v_and_b32 v104, 0x10000, v104
    v_min_u32 v104, v104, v105
    v_sub_u32 v58, v58, v104
    v_cvt_pk_bf16_f32 v72, v120, v121
    v_lshlrev_b32 v120, 1, v72
    v_and_b32 v121, 0x7fff0000, v72
    v_and_b32 v120, 0x10000, v120
    v_min_u32 v120, v120, v121
    v_sub_u32 v72, v72, v120
    v_cvt_pk_bf16_f32 v62, v106, v107
    v_lshlrev_b32 v106, 1, v62
    v_and_b32 v107, 0x7fff0000, v62
    v_and_b32 v106, 0x10000, v106
    v_min_u32 v106, v106, v107
    v_sub_u32 v62, v62, v106
    v_cvt_pk_bf16_f32 v73, v122, v123
    v_lshlrev_b32 v122, 1, v73
    v_and_b32 v123, 0x7fff0000, v73
    v_and_b32 v122, 0x10000, v122
    v_min_u32 v122, v122, v123
    v_sub_u32 v73, v73, v122
    v_cvt_pk_bf16_f32 v66, v108, v109
    v_lshlrev_b32 v108, 1, v66
    v_and_b32 v109, 0x7fff0000, v66
    v_and_b32 v108, 0x10000, v108
    v_min_u32 v108, v108, v109
    v_sub_u32 v66, v66, v108
    v_cvt_pk_bf16_f32 v74, v124, v125
    v_lshlrev_b32 v124, 1, v74
    v_and_b32 v125, 0x7fff0000, v74
    v_and_b32 v124, 0x10000, v124
    v_min_u32 v124, v124, v125
    v_sub_u32 v74, v74, v124
    v_cvt_pk_bf16_f32 v70, v110, v111
    v_lshlrev_b32 v110, 1, v70
    v_and_b32 v111, 0x7fff0000, v70
    v_and_b32 v110, 0x10000, v110
    v_min_u32 v110, v110, v111
    v_sub_u32 v70, v70, v110
    v_cvt_pk_bf16_f32 v75, v126, v127
    v_lshlrev_b32 v126, 1, v75
    v_and_b32 v127, 0x7fff0000, v75
    v_and_b32 v126, 0x10000, v126
    v_min_u32 v126, v126, v127
    v_sub_u32 v75, v75, v126
    ds_write_b64 v38, v[72:73] offset:57344
    ds_write_b64 v39, v[74:75] offset:57344
    v_cvt_pk_bf16_f32 v112, 0, v112
    v_cvt_pk_bf16_f32 v113, 0, v113
    v_cvt_pk_bf16_f32 v114, 0, v114
    v_cvt_pk_bf16_f32 v115, 0, v115
    v_cvt_pk_bf16_f32 v116, 0, v116
    v_cvt_pk_bf16_f32 v117, 0, v117
    v_cvt_pk_bf16_f32 v118, 0, v118
    v_cvt_pk_bf16_f32 v119, 0, v119
    s_waitcnt vmcnt(0) lgkmcnt(0)
    s_barrier
    ds_read_b64 v[20:21], v38 offset:14336
    ds_read_b64 v[24:25], v38 offset:28672
    ds_read_b64 v[28:29], v38 offset:43008
    ds_read_b64 v[22:23], v39 offset:14336
    ds_read_b64 v[26:27], v39 offset:28672
    ds_read_b64 v[30:31], v39 offset:43008
    ds_read_b128 v[84:87], v5 offset:57344
    s_waitcnt lgkmcnt(4)
    v_lshlrev_b32 v76, 16, v20
    v_and_b32 v77, 0xffff0000, v20
    v_lshlrev_b32 v78, 16, v24
    v_and_b32 v79, 0xffff0000, v24
    v_lshlrev_b32 v80, 16, v28
    v_and_b32 v81, 0xffff0000, v28
    v_mul_f32 v76, v76, v112
    v_mul_f32 v77, v77, v113
    v_mul_f32 v78, v78, v112
    v_mul_f32 v79, v79, v113
    v_mul_f32 v80, v80, v112
    v_mul_f32 v81, v81, v113
    v_cvt_pk_bf16_f32 v76, 0, v76
    v_perm_b32 v57, v79, v78, s8
    v_perm_b32 v59, v81, v80, s8
    v_perm_b32 v56, v77, v76, s8
    ds_write_b128 v9, v[56:59] offset:0
    v_lshlrev_b32 v76, 16, v21
    v_and_b32 v77, 0xffff0000, v21
    v_lshlrev_b32 v78, 16, v25
    v_and_b32 v79, 0xffff0000, v25
    v_lshlrev_b32 v80, 16, v29
    v_and_b32 v81, 0xffff0000, v29
    v_mul_f32 v76, v76, v114
    v_mul_f32 v77, v77, v115
    v_mul_f32 v78, v78, v114
    v_mul_f32 v79, v79, v115
    v_mul_f32 v80, v80, v114
    v_mul_f32 v81, v81, v115
    v_cvt_pk_bf16_f32 v76, 0, v76
    v_perm_b32 v61, v79, v78, s8
    v_perm_b32 v63, v81, v80, s8
    v_perm_b32 v60, v77, v76, s8
    ds_write_b128 v10, v[60:63] offset:0
    s_waitcnt lgkmcnt(2)
    buffer_store_dwordx4 v[84:87], v35, s[52:55], s7 offen sc1
    v_lshlrev_b32 v76, 16, v22
    v_and_b32 v77, 0xffff0000, v22
    v_lshlrev_b32 v78, 16, v26
    v_and_b32 v79, 0xffff0000, v26
    v_lshlrev_b32 v80, 16, v30
    v_and_b32 v81, 0xffff0000, v30
    v_mul_f32 v76, v76, v116
    v_mul_f32 v77, v77, v117
    v_mul_f32 v78, v78, v116
    v_mul_f32 v79, v79, v117
    v_mul_f32 v80, v80, v116
    v_mul_f32 v81, v81, v117
    v_cvt_pk_bf16_f32 v76, 0, v76
    v_perm_b32 v65, v79, v78, s8
    v_perm_b32 v67, v81, v80, s8
    v_perm_b32 v64, v77, v76, s8
    ds_write_b128 v9, v[64:67] offset:128
    v_lshlrev_b32 v76, 16, v23
    v_and_b32 v77, 0xffff0000, v23
    v_lshlrev_b32 v78, 16, v27
    v_and_b32 v79, 0xffff0000, v27
    v_lshlrev_b32 v80, 16, v31
    v_and_b32 v81, 0xffff0000, v31
    v_mul_f32 v76, v76, v118
    v_mul_f32 v77, v77, v119
    v_mul_f32 v78, v78, v118
    v_mul_f32 v79, v79, v119
    v_mul_f32 v80, v80, v118
    v_mul_f32 v81, v81, v119
    v_cvt_pk_bf16_f32 v76, 0, v76
    v_perm_b32 v69, v79, v78, s8
    v_perm_b32 v71, v81, v80, s8
    v_perm_b32 v68, v77, v76, s8
    ds_write_b128 v10, v[68:71] offset:128
    ds_read_b128 v[88:91], v11 offset:0
    ds_read_b128 v[92:95], v1 offset:1024
    ds_read_b128 v[96:99], v11 offset:2048
    ds_read_b128 v[100:103], v1 offset:3072
    s_waitcnt lgkmcnt(3)
    buffer_store_dwordx4 v[88:91], v34, s[48:51], s11 offen offset:0 sc1
    s_waitcnt lgkmcnt(2)
    buffer_store_dwordx4 v[92:95], v34, s[48:51], s11 offen offset:2048 sc1
    s_waitcnt lgkmcnt(1)
    buffer_store_dwordx4 v[96:99], v34, s[48:51], s12 offen offset:0 sc1
    s_waitcnt lgkmcnt(0)
    buffer_store_dwordx4 v[100:103], v34, s[48:51], s12 offen offset:2048 sc1
    s_endpgm
K1_M_IDLE:
    s_waitcnt vmcnt(0)
    s_barrier
    s_endpgm
K1_TAB:
    s_sub_u32 s4, s2, 250
    s_lshl_b32 s4, s4, 4
    s_add_u32 s4, s4, s3
    v_and_b32 v4, 7, v2
    v_lshlrev_b32 v4, 2, v4
    s_waitcnt lgkmcnt(0)
    s_mov_b32 s48, s32
    s_and_b32 s49, s33, 0xffff
    s_mov_b32 s50, 18874368
    s_mov_b32 s51, 0x00020000
    s_mov_b32 s36, s24
    s_and_b32 s37, s25, 0xffff
    s_mov_b32 s38, 32
    s_mov_b32 s39, 0x00020000
    buffer_load_dword v5, v4, s[36:39], 0 offen
    s_movk_i32 s5, 1997
    s_mov_b32 s8, 17825792
K1_T_LOOP:
    s_lshl_b32 s9, s4, 6
    v_add_u32 v3, s9, v2
    v_lshrrev_b32 v6, 3, v3
    v_add_u32 v7, 14544, v6
    v_lshlrev_b32 v7, 16, v7
    v_rcp_f32 v8, v7
    v_mul_f32 v9, 0x40490fdb, v7
    v_cvt_pk_bf16_f32 v9, 0, v9
    v_mul_f32 v9, 0x3e4ccccd, v9
    v_cvt_pk_bf16_f32 v9, 0, v9
    v_mul_f32 v9, 0.15915494, v9
    v_cos_f32 v9, v9
    s_nop 0
    v_cvt_pk_bf16_f32 v9, 0, v9
    v_add_f32 v9, 1.0, v9
    v_cvt_pk_bf16_f32 v9, 0, v9
    v_mul_f32 v9, 0.5, v9
    v_cmp_lt_u32 vcc, 1, v6
    v_cmp_gt_u32 s[6:7], s5, v6
    s_nop 0
    s_and_b64 vcc, vcc, s[6:7]
    v_cndmask_b32 v9, 0, v9, vcc
    s_waitcnt vmcnt(0)
    v_lshlrev_b32 v10, 16, v5
    v_and_b32 v11, 0xffff0000, v5
    v_mul_f32 v10, v10, v7
    v_mul_f32 v11, v11, v7
    v_cvt_pk_bf16_f32 v10, 0, v10
    v_cvt_pk_bf16_f32 v11, 0, v11
    v_mul_f32 v10, 0.15915494, v10
    v_mul_f32 v11, 0.15915494, v11
    v_fract_f32 v10, v10
    v_fract_f32 v11, v11
    v_sin_f32 v10, v10
    v_sin_f32 v11, v11
    v_cvt_pk_bf16_f32 v10, 0, v10
    v_cvt_pk_bf16_f32 v11, 0, v11
    v_mul_f32 v10, v10, v8
    v_mul_f32 v11, v11, v8
    v_cvt_pk_bf16_f32 v10, 0, v10
    v_cvt_pk_bf16_f32 v11, 0, v11
    v_mul_f32 v10, v10, v9
    v_mul_f32 v11, v11, v9
    v_cvt_pk_bf16_f32 v10, v10, v11
    v_lshlrev_b32 v3, 2, v3
    buffer_store_dword v10, v3, s[48:51], s8 offen
    s_add_u32 s4, s4, 96
    s_cmp_lt_u32 s4, 256
    s_cbranch_scc1 K1_T_LOOP
    s_cmp_ge_u32 s4, 259
    s_cbranch_scc1 K1_END
    s_mov_b32 s36, s30
    s_and_b32 s37, s31, 0xffff
    s_mov_b32 s38, 6144
    s_mov_b32 s39, 0x00020000
    s_sub_u32 s4, s4, 256
    v_and_b32 v4, 31, v2
    v_lshlrev_b32 v4, 2, v4
    v_lshrrev_b32 v5, 5, v2
    v_mul_u32_u24 v5, 3072, v5
    v_add_u32 v4, v4, v5
    s_lshl_b32 s5, s4, 7
    buffer_load_dword v12, v4, s[36:39], s5 offen offset:0
    buffer_load_dword v13, v4, s[36:39], s5 offen offset:384
    buffer_load_dword v14, v4, s[36:39], s5 offen offset:768
    buffer_load_dword v15, v4, s[36:39], s5 offen offset:1152
    buffer_load_dword v16, v4, s[36:39], s5 offen offset:1536
    buffer_load_dword v17, v4, s[36:39], s5 offen offset:1920
    buffer_load_dword v18, v4, s[36:39], s5 offen offset:2304
    buffer_load_dword v19, v4, s[36:39], s5 offen offset:2688
    s_mov_b32 s6, 0x05040100
    s_mov_b32 s7, 0x07060302
    s_lshl_b32 s5, s4, 11
    s_add_u32 s5, s5, 17891328
    v_lshlrev_b32 v4, 4, v2
    s_waitcnt vmcnt(0)
    v_perm_b32 v20, v13, v12, s6
    v_perm_b32 v24, v13, v12, s7
    v_perm_b32 v21, v15, v14, s6
    v_perm_b32 v25, v15, v14, s7
    v_perm_b32 v22, v17, v16, s6
    v_perm_b32 v26, v17, v16, s7
    v_perm_b32 v23, v19, v18, s6
    v_perm_b32 v27, v19, v18, s7
    buffer_store_dwordx4 v[20:23], v4, s[48:51], s5 offen
    buffer_store_dwordx4 v[24:27], v4, s[48:51], s5 offen offset:1024
K1_END:
    s_endpgm
.globl painn_msg_kernel
.p2align 8
.type painn_msg_kernel,@function
painn_msg_kernel:
    s_cmp_ge_u32 s2, 256
    s_cbranch_scc1 K2_END
    s_load_dwordx2 s[24:25], s[0:1], 80
    s_load_dwordx2 s[16:17], s[0:1], 0
    s_load_dwordx2 s[22:23], s[0:1], 64
    v_lshrrev_b32 v9, 6, v0
    v_lshrrev_b32 v60, 4, v0
    v_lshlrev_b32 v61, 2, v60
    v_and_b32 v6, 63, v0
    v_readfirstlane_b32 s3, v9
    v_lshlrev_b32 v6, 4, v6
    s_and_b32 s4, s2, 7
    s_lshl_b32 s4, s4, 5
    s_lshr_b32 s7, s2, 3
    s_or_b32 s7, s7, s4
    s_lshl_b32 s4, s7, 10
    s_lshl_b32 s7, s7, 9
    s_add_u32 s4, s4, 16777216
    s_mov_b32 s11, 0
    s_waitcnt lgkmcnt(0)
    s_mov_b32 s36, s24
    s_and_b32 s37, s25, 0xffff
    s_mov_b32 s38, 18874368
    s_mov_b32 s39, 0x00020000
    buffer_load_dwordx4 v[80:83], v6, s[36:39], s4 offen
K2_ROUND:
    buffer_load_dword v64, v61, s[36:39], s4 offen offset:0
    buffer_load_dword v65, v61, s[36:39], s4 offen offset:128
    buffer_load_dword v66, v61, s[36:39], s4 offen offset:256
    buffer_load_dword v67, v61, s[36:39], s4 offen offset:384
    buffer_load_dword v68, v61, s[36:39], s4 offen offset:512
    v_lshlrev_b32 v12, 2, v0
    v_and_b32 v13, 0x11f, v0
    v_cmp_eq_u32 vcc, 0x11f, v13
    s_nop 1
    v_cndmask_b32 v13, 0, 32, vcc
    ds_write_b32 v12, v13 offset:256
    s_cmp_lg_u32 s11, 0
    s_cbranch_scc1 K2_R2
    s_lshl_b32 s6, s3, 10
    s_add_u32 s5, s6, 84992
    s_add_u32 s6, s6, 17825792
    s_mov_b32 m0, s5
    s_add_u32 s5, s5, 8192
    buffer_load_dwordx4 v6, s[36:39], s6 offen lds
    s_add_u32 s6, s6, 8192
    s_mov_b32 m0, s5
    s_add_u32 s5, s5, 8192
    buffer_load_dwordx4 v6, s[36:39], s6 offen lds
    s_add_u32 s6, s6, 8192
    s_mov_b32 m0, s5
    s_add_u32 s5, s5, 8192
    buffer_load_dwordx4 v6, s[36:39], s6 offen lds
    s_add_u32 s6, s6, 8192
    s_mov_b32 m0, s5
    s_add_u32 s5, s5, 8192
    buffer_load_dwordx4 v6, s[36:39], s6 offen lds
    s_add_u32 s6, s6, 8192
    s_mov_b32 s44, s16
    s_and_b32 s45, s17, 0xffff
    s_mov_b32 s46, 5120000
    s_mov_b32 s47, 0x00020000
    s_mov_b32 s40, s24
    s_and_b32 s41, s25, 0xffff
    s_mov_b32 s42, 320000
    s_mov_b32 s43, 0x00020000
    s_or_b32 s41, s41, 0x100000
    s_add_u32 s52, s24, 6291456
    s_addc_u32 s53, s25, 0
    s_mov_b32 s52, s52
    s_and_b32 s53, s53, 0xffff
    s_mov_b32 s54, 320000
    s_mov_b32 s55, 0x00020000
    s_or_b32 s53, s53, 0x40000
    s_mov_b32 s48, s22
    s_and_b32 s49, s23, 0xffff
    s_mov_b32 s50, 5120000
    s_mov_b32 s51, 0x00020000
    v_and_b32 v70, 31, v0
    v_bfe_u32 v71, v0, 5, 1
    v_lshlrev_b32 v1, 4, v70
    v_mov_b32 v2, v70
    v_lshlrev_b32 v5, 4, v71
    v_add_u32 v5, 84992, v5
    v_mov_b64 v[24:25], 0
    v_mov_b64 v[26:27], 0
    v_mov_b64 v[28:29], 0
    v_mov_b64 v[30:31], 0
    v_mov_b64 v[120:121], 0
    v_mov_b64 v[122:123], 0
    v_mov_b64 v[124:125], 0
    v_mov_b64 v[126:127], 0
    v_mov_b64 v[128:129], 0
    v_mov_b64 v[130:131], 0
    v_mov_b64 v[132:133], 0
    v_mov_b64 v[134:135], 0
    v_mov_b64 v[136:137], 0
    v_mov_b64 v[138:139], 0
    v_mov_b64 v[140:141], 0
    v_mov_b64 v[142:143], 0
    v_mov_b64 v[144:145], 0
    v_mov_b64 v[146:147], 0
    v_mov_b64 v[148:149], 0
    v_mov_b64 v[150:151], 0
    v_mov_b64 v[152:153], 0
    v_mov_b64 v[154:155], 0
    v_mov_b64 v[156:157], 0
    v_mov_b64 v[158:159], 0
    s_waitcnt lgkmcnt(0)
    s_barrier
    s_waitcnt vmcnt(4)
    s_branch K2_R3
K2_R2:
    s_waitcnt vmcnt(0) lgkmcnt(0)
    s_barrier
K2_R3:
    v_and_b32 v14, 15, v0
    v_add_u32 v14, s11, v14
    v_mul_u32_u24 v13, 49152, v60
    s_mov_b32 s5, 8388608
    v_lshrrev_b32 v15, 16, v64
    v_and_b32 v16, 0xffff, v64
    v_add_u32 v16, v16, v14
    v_mad_u32_u24 v72, v16, 12, v13
    v_sub_u32 v64, v15, v14
    v_cmp_lt_i32 s[56:57], 0, v64
    s_nop 0
    s_mov_b64 exec, s[56:57]
    s_cbranch_execz K2_L0_0
    buffer_load_dwordx3 v[160:162], v72, s[36:39], s5 offen
K2_L0_0:
    s_mov_b64 exec, -1
    s_add_u32 s5, s5, 1572864
    v_lshrrev_b32 v15, 16, v65
    v_and_b32 v16, 0xffff, v65
    v_add_u32 v16, v16, v14
    v_mad_u32_u24 v73, v16, 12, v13
    v_sub_u32 v65, v15, v14
    v_cmp_lt_i32 s[60:61], 0, v65
    s_nop 0
    s_mov_b64 exec, s[60:61]
    s_cbranch_execz K2_L1_0
    buffer_load_dwordx3 v[168:170], v73, s[36:39], s5 offen
K2_L1_0:
    s_mov_b64 exec, -1
    s_add_u32 s5, s5, 1572864
    v_lshrrev_b32 v15, 16, v66
    v_and_b32 v16, 0xffff, v66
    v_add_u32 v16, v16, v14
    v_mad_u32_u24 v74, v16, 12, v13
    v_sub_u32 v66, v15, v14
    v_cmp_lt_i32 s[64:65], 0, v66
    s_nop 0
    s_mov_b64 exec, s[64:65]
    s_cbranch_execz K2_L2_0
    buffer_load_dwordx3 v[176:178], v74, s[36:39], s5 offen
K2_L2_0:
    s_mov_b64 exec, -1
    s_add_u32 s5, s5, 1572864
    v_lshrrev_b32 v15, 16, v67
    v_and_b32 v16, 0xffff, v67
    v_add_u32 v16, v16, v14
    v_mad_u32_u24 v75, v16, 12, v13
    v_sub_u32 v67, v15, v14
    v_cmp_lt_i32 s[68:69], 0, v67
    s_nop 0
    s_mov_b64 exec, s[68:69]
    s_cbranch_execz K2_L3_0
    buffer_load_dwordx3 v[184:186], v75, s[36:39], s5 offen
K2_L3_0:
    s_mov_b64 exec, -1
    s_add_u32 s5, s5, 1572864
    v_lshrrev_b32 v15, 16, v68
    v_and_b32 v16, 0xffff, v68
    v_add_u32 v16, v16, v14
    v_mad_u32_u24 v76, v16, 12, v13
    v_sub_u32 v68, v15, v14
    v_cmp_lt_i32 s[72:73], 0, v68
    s_nop 0
    s_mov_b64 exec, s[72:73]
    s_cbranch_execz K2_L4_0
    buffer_load_dwordx3 v[192:194], v76, s[36:39], s5 offen
K2_L4_0:
    s_mov_b64 exec, -1
    s_add_u32 s5, s5, 1572864
    s_cmp_lg_u32 s11, 0
    s_cbranch_scc1 K2_R9
    v_cmp_gt_u32 vcc, 640, v6
    s_nop 1
    v_cndmask_b32 v80, 0, v80, vcc
    v_cndmask_b32 v81, 0, v81, vcc
    v_cndmask_b32 v82, 0, v82, vcc
    v_cndmask_b32 v83, 0, v83, vcc
    v_lshrrev_b32 v80, 16, v80
    v_lshrrev_b32 v81, 16, v81
    v_lshrrev_b32 v82, 16, v82
    v_lshrrev_b32 v83, 16, v83
    v_max3_u32 v70, v80, v81, v82
    v_add3_u32 v71, v80, v81, v82
    v_max_u32 v70, v70, v83
    v_add_u32 v71, v71, v83
    s_nop 0
    v_max_u32_dpp v70, v70, v70 row_shr:1 row_mask:0xf bank_mask:0xf bound_ctrl:0
    v_add_u32_dpp v71, v71, v71 row_shr:1 row_mask:0xf bank_mask:0xf bound_ctrl:0
    s_nop 0
    v_max_u32_dpp v70, v70, v70 row_shr:2 row_mask:0xf bank_mask:0xf bound_ctrl:0
    v_add_u32_dpp v71, v71, v71 row_shr:2 row_mask:0xf bank_mask:0xf bound_ctrl:0
    s_nop 0
    v_max_u32_dpp v70, v70, v70 row_shr:4 row_mask:0xf bank_mask:0xf bound_ctrl:0
    v_add_u32_dpp v71, v71, v71 row_shr:4 row_mask:0xf bank_mask:0xf bound_ctrl:0
    s_nop 0
    v_max_u32_dpp v70, v70, v70 row_shr:8 row_mask:0xf bank_mask:0xf bound_ctrl:0
    v_add_u32_dpp v71, v71, v71 row_shr:8 row_mask:0xf bank_mask:0xf bound_ctrl:0
    s_nop 0
    v_max_u32_dpp v70, v70, v70 row_bcast:15 row_mask:0xa bank_mask:0xf
    v_add_u32_dpp v71, v71, v71 row_bcast:15 row_mask:0xa bank_mask:0xf
    s_nop 0
    v_max_u32_dpp v70, v70, v70 row_bcast:31 row_mask:0xc bank_mask:0xf
    v_add_u32_dpp v71, v71, v71 row_bcast:31 row_mask:0xc bank_mask:0xf
    v_readlane_b32 s8, v70, 63
    v_readlane_b32 s9, v71, 63
    s_mov_b32 s10, 32
    s_cmp_gt_u32 s9, 2752
    s_cselect_b32 s10, 16, s10
    s_min_u32 s9, s9, 2752
    s_add_u32 s9, s9, 576
    s_lshl_b32 s9, s9, 4
K2_R9:
    v_cmp_lt_i32 s[58:59], 16, v64
    v_cmp_lt_i32 s[62:63], 16, v65
    v_cmp_lt_i32 s[66:67], 16, v66
    v_cmp_lt_i32 s[70:71], 16, v67
    v_cmp_lt_i32 s[74:75], 16, v68
    s_or_b64 s[30:31], s[58:59], s[62:63]
    s_or_b64 s[30:31], s[30:31], s[66:67]
    s_or_b64 s[30:31], s[30:31], s[70:71]
    s_or_b64 s[30:31], s[30:31], s[74:75]
    s_cselect_b32 s15, 1, 0
    s_cmp_gt_u32 s10, 16
    s_cselect_b32 s15, s15, 0
    s_cmp_eq_u32 s15, 0
    s_cbranch_scc1 K2_LZ
    s_mov_b32 s5, 8388608
    s_mov_b64 exec, s[58:59]
    s_cbranch_execz K2_L0_1
    buffer_load_dwordx3 v[164:166], v72, s[36:39], s5 offen offset:192
K2_L0_1:
    s_add_u32 s5, s5, 1572864
    s_mov_b64 exec, s[62:63]
    s_cbranch_execz K2_L1_1
    buffer_load_dwordx3 v[172:174], v73, s[36:39], s5 offen offset:192
K2_L1_1:
    s_add_u32 s5, s5, 1572864
    s_mov_b64 exec, s[66:67]
    s_cbranch_execz K2_L2_1
    buffer_load_dwordx3 v[180:182], v74, s[36:39], s5 offen offset:192
K2_L2_1:
    s_add_u32 s5, s5, 1572864
    s_mov_b64 exec, s[70:71]
    s_cbranch_execz K2_L3_1
    buffer_load_dwordx3 v[188:190], v75, s[36:39], s5 offen offset:192
K2_L3_1:
    s_add_u32 s5, s5, 1572864
    s_mov_b64 exec, s[74:75]
    s_cbranch_execz K2_L4_1
    buffer_load_dwordx3 v[196:198], v76, s[36:39], s5 offen offset:192
K2_L4_1:
    s_add_u32 s5, s5, 1572864
K2_LZ:
    s_mov_b64 exec, -1
    v_mov_b32 v16, 0
    v_mov_b32 v17, 0
    v_mov_b32 v18, 0
    v_mov_b32 v19, 0x7f000000
    v_lshlrev_b32 v12, 4, v0
    s_lshl_b32 s5, s3, 10
K2_PF:
    ds_write_b128 v12, v[16:19] offset:30720
    s_add_u32 s5, s5, 8192
    s_nop 0
    v_add_u32 v12, 8192, v12
    s_cmp_lt_u32 s5, s9
    s_cbranch_scc1 K2_PF
    v_mov_b32 v14, 1
    v_lshrrev_b32 v62, 2, v6
    s_mov_b32 s28, -1
    s_mov_b32 s29, 0xff
    v_and_b32 v72, 3, v0
    v_bfe_u32 v73, v0, 3, 2
    v_lshl_add_u32 v72, v73, 2, v72
    v_bfe_u32 v73, v0, 2, 1
    v_lshl_add_u32 v72, v72, 1, v73
    v_lshlrev_b32 v4, 4, v72
    s_waitcnt vmcnt(0)
    s_mov_b64 exec, s[56:57]
    v_and_b32 v208, 0x3fc, v161
    ds_add_rtn_u32 v220, v208, v14 offset:256
    s_mov_b64 exec, s[60:61]
    v_and_b32 v210, 0x3fc, v169
    ds_add_rtn_u32 v222, v210, v14 offset:256
    s_mov_b64 exec, s[64:65]
    v_and_b32 v212, 0x3fc, v177
    ds_add_rtn_u32 v224, v212, v14 offset:256
    s_mov_b64 exec, s[68:69]
    v_and_b32 v214, 0x3fc, v185
    ds_add_rtn_u32 v226, v214, v14 offset:256
    s_mov_b64 exec, s[72:73]
    v_and_b32 v216, 0x3fc, v193
    ds_add_rtn_u32 v228, v216, v14 offset:256
    s_cmp_eq_u32 s15, 0
    s_cbranch_scc1 K2_HZ
    s_mov_b64 exec, s[58:59]
    v_and_b32 v209, 0x3fc, v165
    ds_add_rtn_u32 v221, v209, v14 offset:256
    s_mov_b64 exec, s[62:63]
    v_and_b32 v211, 0x3fc, v173
    ds_add_rtn_u32 v223, v211, v14 offset:256
    s_mov_b64 exec, s[66:67]
    v_and_b32 v213, 0x3fc, v181
    ds_add_rtn_u32 v225, v213, v14 offset:256
    s_mov_b64 exec, s[70:71]
    v_and_b32 v215, 0x3fc, v189
    ds_add_rtn_u32 v227, v215, v14 offset:256
    s_mov_b64 exec, s[74:75]
    v_and_b32 v217, 0x3fc, v197
    ds_add_rtn_u32 v229, v217, v14 offset:256
K2_HZ:
    s_mov_b64 exec, -1
    v_and_b32 v163, 65535, v162
    v_and_b32 v162, 0xffff0000, v162
    v_lshlrev_b32 v163, 5, v163
    v_add_u32 v208, v208, v208
    v_and_b32 v171, 65535, v170
    v_and_b32 v170, 0xffff0000, v170
    v_lshlrev_b32 v171, 5, v171
    v_add_u32 v210, v210, v210
    v_and_b32 v179, 65535, v178
    v_and_b32 v178, 0xffff0000, v178
    v_lshlrev_b32 v179, 5, v179
    v_add_u32 v212, v212, v212
    v_and_b32 v187, 65535, v186
    v_and_b32 v186, 0xffff0000, v186
    v_lshlrev_b32 v187, 5, v187
    v_add_u32 v214, v214, v214
    v_and_b32 v195, 65535, v194
    v_and_b32 v194, 0xffff0000, v194
    v_lshlrev_b32 v195, 5, v195
    v_add_u32 v216, v216, v216
    s_waitcnt lgkmcnt(0)
    s_barrier
    s_cmp_eq_u32 s3, 0
    s_cbranch_scc1 K2_W0
    s_cmp_lg_u32 s11, 0
    s_cbranch_scc1 K2_W1
    s_lshl_b32 s6, s3, 10
    s_add_u32 s5, s6, 116736
    s_add_u32 s6, s6, 17857536
    s_mov_b32 m0, s5
    s_add_u32 s5, s5, 7168
    buffer_load_dwordx4 v6, s[36:39], s6 offen lds
    s_add_u32 s6, s6, 7168
    s_mov_b32 m0, s5
    s_add_u32 s5, s5, 7168
    buffer_load_dwordx4 v6, s[36:39], s6 offen lds
    s_add_u32 s6, s6, 7168
    s_mov_b32 m0, s5
    s_add_u32 s5, s5, 7168
    buffer_load_dwordx4 v6, s[36:39], s6 offen lds
    s_add_u32 s6, s6, 7168
    s_mov_b32 m0, s5
    s_add_u32 s5, s5, 7168
    buffer_load_dwordx4 v6, s[36:39], s6 offen lds
    s_add_u32 s6, s6, 7168
    s_mov_b32 m0, s5
    s_add_u32 s5, s5, 7168
    buffer_load_dwordx4 v6, s[36:39], s6 offen lds
    s_add_u32 s6, s6, 7168
    s_mov_b32 m0, s5
    s_add_u32 s5, s5, 7168
    buffer_load_dwordx4 v6, s[36:39], s6 offen lds
    s_add_u32 s6, s6, 7168
    s_branch K2_W1
K2_W0:
    s_setprio 3
    ds_read_b32 v64, v62 offset:256
    ds_read_b32 v65, v62 offset:416
    ds_read_b32 v66, v62 offset:576
    ds_read_b32 v67, v62 offset:736
    ds_read_b32 v68, v62 offset:896
    ds_read_b32 v69, v62 offset:1056
    ds_read_b32 v63, v62 offset:5632
    v_mov_b32 v73, 0
    v_mov_b32 v74, 0
    v_mov_b32 v75, 0
    v_mov_b32 v248, 0x76543210
    v_mov_b32 v249, 0x32170564
    v_mov_b32 v250, 0x76534210
    v_mov_b32 v251, 0x46571203
    v_mov_b32 v252, 0x1234567
    s_waitcnt lgkmcnt(0)
    v_mov_b32 v232, v64
    v_add_u32 v233, v232, v65
    v_add_u32 v234, v233, v66
    v_add_u32 v235, v234, v67
    v_add_u32 v236, v235, v68
    v_add_u32 v237, v236, v69
    v_add_u32 v72, 1, v237
    v_and_b32 v72, -2, v72
    v_and_b32 v240, -2, v232
    v_and_b32 v241, -2, v233
    v_and_b32 v242, -2, v234
    v_and_b32 v243, -2, v235
    v_and_b32 v244, -2, v236
    v_sub_u32 v245, v72, v244
    v_sub_u32 v244, v244, v243
    v_sub_u32 v243, v243, v242
    v_sub_u32 v242, v242, v241
    v_sub_u32 v241, v241, v240
    s_cmp_lg_u32 s11, 0
    s_cbranch_scc1 K2_R7
    v_lshl_add_u32 v72, v72, 8, v62
    ds_write_b32 v62, v72 offset:5376
    ds_read_b128 v[80:83], v73 offset:5376
    ds_read_b128 v[84:87], v73 offset:5392
    ds_read_b128 v[88:91], v73 offset:5408
    ds_read_b128 v[92:95], v73 offset:5424
    ds_read_b128 v[96:99], v73 offset:5440
    ds_read_b128 v[100:103], v73 offset:5456
    ds_read_b128 v[104:107], v73 offset:5472
    ds_read_b128 v[108:111], v73 offset:5488
    ds_read_b128 v[112:115], v73 offset:5504
    ds_read_b128 v[116:119], v73 offset:5520
    s_waitcnt lgkmcnt(7)
    v_sub_u32 v80, v72, v80
    v_sub_u32 v81, v72, v81
    v_sub_u32 v82, v72, v82
    v_sub_u32 v83, v72, v83
    v_alignbit_b32 v74, v74, v80, 31
    v_alignbit_b32 v75, v75, v81, 31
    v_alignbit_b32 v74, v74, v82, 31
    v_alignbit_b32 v75, v75, v83, 31
    v_sub_u32 v84, v72, v84
    v_sub_u32 v85, v72, v85
    v_sub_u32 v86, v72, v86
    v_sub_u32 v87, v72, v87
    v_alignbit_b32 v74, v74, v84, 31
    v_alignbit_b32 v75, v75, v85, 31
    v_alignbit_b32 v74, v74, v86, 31
    v_alignbit_b32 v75, v75, v87, 31
    v_sub_u32 v88, v72, v88
    v_sub_u32 v89, v72, v89
    v_sub_u32 v90, v72, v90
    v_sub_u32 v91, v72, v91
    v_alignbit_b32 v74, v74, v88, 31
    v_alignbit_b32 v75, v75, v89, 31
    v_alignbit_b32 v74, v74, v90, 31
    v_alignbit_b32 v75, v75, v91, 31
    s_waitcnt lgkmcnt(4)
    v_sub_u32 v92, v72, v92
    v_sub_u32 v93, v72, v93
    v_sub_u32 v94, v72, v94
    v_sub_u32 v95, v72, v95
    v_alignbit_b32 v74, v74, v92, 31
    v_alignbit_b32 v75, v75, v93, 31
    v_alignbit_b32 v74, v74, v94, 31
    v_alignbit_b32 v75, v75, v95, 31
    v_sub_u32 v96, v72, v96
    v_sub_u32 v97, v72, v97
    v_sub_u32 v98, v72, v98
    v_sub_u32 v99, v72, v99
    v_alignbit_b32 v74, v74, v96, 31
    v_alignbit_b32 v75, v75, v97, 31
    v_alignbit_b32 v74, v74, v98, 31
    v_alignbit_b32 v75, v75, v99, 31
    v_sub_u32 v100, v72, v100
    v_sub_u32 v101, v72, v101
    v_sub_u32 v102, v72, v102
    v_sub_u32 v103, v72, v103
    v_alignbit_b32 v74, v74, v100, 31
    v_alignbit_b32 v75, v75, v101, 31
    v_alignbit_b32 v74, v74, v102, 31
    v_alignbit_b32 v75, v75, v103, 31
    s_waitcnt lgkmcnt(1)
    v_sub_u32 v104, v72, v104
    v_sub_u32 v105, v72, v105
    v_sub_u32 v106, v72, v106
    v_sub_u32 v107, v72, v107
    v_alignbit_b32 v74, v74, v104, 31
    v_alignbit_b32 v75, v75, v105, 31
    v_alignbit_b32 v74, v74, v106, 31
    v_alignbit_b32 v75, v75, v107, 31
    v_sub_u32 v108, v72, v108
    v_sub_u32 v109, v72, v109
    v_sub_u32 v110, v72, v110
    v_sub_u32 v111, v72, v111
    v_alignbit_b32 v74, v74, v108, 31
    v_alignbit_b32 v75, v75, v109, 31
    v_alignbit_b32 v74, v74, v110, 31
    v_alignbit_b32 v75, v75, v111, 31
    v_sub_u32 v112, v72, v112
    v_sub_u32 v113, v72, v113
    v_sub_u32 v114, v72, v114
    v_sub_u32 v115, v72, v115
    v_alignbit_b32 v74, v74, v112, 31
    v_alignbit_b32 v75, v75, v113, 31
    v_alignbit_b32 v74, v74, v114, 31
    v_alignbit_b32 v75, v75, v115, 31
    s_waitcnt lgkmcnt(0)
    v_sub_u32 v116, v72, v116
    v_sub_u32 v117, v72, v117
    v_sub_u32 v118, v72, v118
    v_sub_u32 v119, v72, v119
    v_alignbit_b32 v74, v74, v116, 31
    v_alignbit_b32 v75, v75, v117, 31
    v_alignbit_b32 v74, v74, v118, 31
    v_alignbit_b32 v75, v75, v119, 31
    v_bcnt_u32_b32 v74, v74, 0
    v_bcnt_u32_b32 v74, v75, v74
    v_lshrrev_b32 v75, 3, v74
    v_cmp_eq_u32 s[18:19], 1, v75
    v_cmp_eq_u32 s[20:21], 2, v75
    v_cmp_eq_u32 s[32:33], 3, v75
    v_cmp_eq_u32 s[34:35], 4, v75
    v_lshlrev_b32 v74, 2, v74
    v_cndmask_b32 v248, v248, v249, s[18:19]
    v_cndmask_b32 v248, v248, v250, s[20:21]
    v_cndmask_b32 v248, v248, v251, s[32:33]
    v_cndmask_b32 v248, v248, v252, s[34:35]
    v_bfe_u32 v74, v248, v74, 3
    v_lshl_add_u32 v76, v74, 3, v75
    v_lshlrev_b32 v76, 2, v76
    v_lshl_add_u32 v63, v74, 5, v75
    v_lshlrev_b32 v63, 2, v63
    v_lshl_or_b32 v63, v75, 19, v63
    s_mov_b64 exec, s[28:29]
    ds_write_b32 v76, v62 offset:0
    ds_write_b32 v62, v63 offset:5632
K2_R7:
    s_mov_b64 exec, s[28:29]
    v_and_b32 v72, 0xffff, v63
    ds_write_b32 v72, v240 offset:1280
    ds_write_b32 v72, v241 offset:1300
    ds_write_b32 v72, v242 offset:1320
    ds_write_b32 v72, v243 offset:1340
    ds_write_b32 v72, v244 offset:1360
    ds_write_b32 v72, v245 offset:1380
    s_mov_b64 exec, -1
    ds_read_b128 v[16:19], v6 offset:1280
    v_and_b32 v63, 0xffff0000, v63
    v_and_b32 v232, 1, v232
    v_mul_u32_u24 v81, v232, v64
    v_add_u16 v81, -1, v81
    v_or_b32 v232, v232, v63
    v_and_b32 v233, 1, v233
    v_mul_u32_u24 v83, v233, v65
    v_add_u16 v83, -1, v83
    v_or_b32 v233, v233, v63
    v_and_b32 v234, 1, v234
    v_mul_u32_u24 v85, v234, v66
    v_add_u16 v85, -1, v85
    v_or_b32 v234, v234, v63
    v_and_b32 v235, 1, v235
    v_mul_u32_u24 v87, v235, v67
    v_add_u16 v87, -1, v87
    v_or_b32 v235, v235, v63
    v_and_b32 v236, 1, v236
    v_mul_u32_u24 v89, v236, v68
    v_add_u16 v89, -1, v89
    v_or_b32 v236, v236, v63
    v_mov_b32 v91, 0xffff
    v_lshlrev_b32 v73, 1, v62
    s_waitcnt lgkmcnt(0)
    v_add_u32 v21, v16, v17
    v_add_u32 v22, v21, v18
    v_add_u32 v15, v22, v19
    v_mov_b32 v13, v15
    s_nop 1
    v_add_u32_dpp v13, v13, v13 row_shr:1 row_mask:0xf bank_mask:0xf bound_ctrl:0
    s_nop 1
    v_add_u32_dpp v13, v13, v13 row_shr:2 row_mask:0xf bank_mask:0xf bound_ctrl:0
    s_nop 1
    v_add_u32_dpp v13, v13, v13 row_shr:4 row_mask:0xf bank_mask:0xf bound_ctrl:0
    s_nop 1
    v_add_u32_dpp v13, v13, v13 row_shr:8 row_mask:0xf bank_mask:0xf bound_ctrl:0
    s_nop 1
    v_add_u32_dpp v13, v13, v13 row_bcast:15 row_mask:0xa bank_mask:0xf
    s_nop 1
    v_add_u32_dpp v13, v13, v13 row_bcast:31 row_mask:0xc bank_mask:0xf
    v_sub_u32 v76, v13, v15
    v_add_u32 v79, v76, v22
    v_add_u32 v78, v76, v21
    v_add_u32 v77, v76, v16
    ds_write_b128 v6, v[76:79] offset:2304
    s_mov_b64 exec, s[28:29]
    ds_read_b32 v245, v72 offset:2404
    ds_read_b32 v244, v72 offset:2384
    ds_read_b32 v243, v72 offset:2364
    ds_read_b32 v242, v72 offset:2344
    ds_read_b32 v241, v72 offset:2324
    ds_read_b32 v240, v72 offset:2304
    v_cmp_lt_u32 s[18:19], 0, v65
    v_cmp_lt_u32 s[20:21], 0, v66
    v_cmp_lt_u32 s[32:33], 0, v67
    v_cmp_lt_u32 s[34:35], 0, v68
    s_waitcnt lgkmcnt(0)
    v_add_u32 v90, v245, v236
    ds_write_b64 v73, v[90:91] offset:4928
    v_add_u32 v88, v244, v235
    v_lshl_or_b32 v89, v245, 16, v89
    ds_write_b64 v73, v[88:89] offset:4608
    v_add_u32 v86, v243, v234
    v_cndmask_b32 v244, v245, v244, s[34:35]
    v_lshl_or_b32 v87, v244, 16, v87
    ds_write_b64 v73, v[86:87] offset:4288
    v_add_u32 v84, v242, v233
    v_cndmask_b32 v243, v244, v243, s[32:33]
    v_lshl_or_b32 v85, v243, 16, v85
    ds_write_b64 v73, v[84:85] offset:3968
    v_add_u32 v82, v241, v232
    v_cndmask_b32 v242, v243, v242, s[20:21]
    v_lshl_or_b32 v83, v242, 16, v83
    ds_write_b64 v73, v[82:83] offset:3648
    v_add_u32 v80, v240, v63
    v_cndmask_b32 v241, v242, v241, s[18:19]
    v_lshl_or_b32 v81, v241, 16, v81
    ds_write_b64 v73, v[80:81] offset:3328
    s_mov_b64 exec, -1
    s_waitcnt lgkmcnt(0)
    s_barrier
    s_branch K2_W2
K2_W1:
    s_lshr_b32 s5, s2, 3
    s_cmp_lg_u32 s11, 0
    s_cselect_b32 s5, 0x4000, s5
    s_mul_i32 s6, s5, 32768
    v_subrev_u32 v233, 64, v0
    v_lshlrev_b32 v235, 7, v233
    v_cmp_gt_u32 vcc, 256, v233
    s_nop 1
    v_cndmask_b32 v234, -1, v235, vcc
    buffer_load_dword v7, v234, s[36:39], s6 offen
    s_mul_i32 s6, s5, 8192
    s_add_u32 s6, s6, 6291456
    v_cmp_gt_u32 vcc, 64, v233
    s_nop 1
    v_cndmask_b32 v234, -1, v235, vcc
    buffer_load_dword v7, v234, s[36:39], s6 offen
    s_barrier
K2_W2:
    s_mov_b64 exec, s[56:57]
    ds_read_b64 v[96:97], v208 offset:3328
    s_mov_b64 exec, s[60:61]
    ds_read_b64 v[100:101], v210 offset:3328
    s_mov_b64 exec, s[64:65]
    ds_read_b64 v[104:105], v212 offset:3328
    s_mov_b64 exec, s[68:69]
    ds_read_b64 v[108:109], v214 offset:3328
    s_mov_b64 exec, s[72:73]
    ds_read_b64 v[112:113], v216 offset:3328
    s_cmp_eq_u32 s15, 0
    s_cbranch_scc1 K2_TZ
    s_mov_b64 exec, -1
    v_and_b32 v167, 65535, v166
    v_and_b32 v166, 0xffff0000, v166
    v_lshlrev_b32 v167, 5, v167
    v_add_u32 v209, v209, v209
    v_and_b32 v175, 65535, v174
    v_and_b32 v174, 0xffff0000, v174
    v_lshlrev_b32 v175, 5, v175
    v_add_u32 v211, v211, v211
    v_and_b32 v183, 65535, v182
    v_and_b32 v182, 0xffff0000, v182
    v_lshlrev_b32 v183, 5, v183
    v_add_u32 v213, v213, v213
    v_and_b32 v191, 65535, v190
    v_and_b32 v190, 0xffff0000, v190
    v_lshlrev_b32 v191, 5, v191
    v_add_u32 v215, v215, v215
    v_and_b32 v199, 65535, v198
    v_and_b32 v198, 0xffff0000, v198
    v_lshlrev_b32 v199, 5, v199
    v_add_u32 v217, v217, v217
    s_mov_b64 exec, s[58:59]
    ds_read_b64 v[98:99], v209 offset:3328
    s_mov_b64 exec, s[62:63]
    ds_read_b64 v[102:103], v211 offset:3328
    s_mov_b64 exec, s[66:67]
    ds_read_b64 v[106:107], v213 offset:3328
    s_mov_b64 exec, s[70:71]
    ds_read_b64 v[110:111], v215 offset:3328
    s_mov_b64 exec, s[74:75]
    ds_read_b64 v[114:115], v217 offset:3328
K2_TZ:
    s_mov_b64 exec, -1
    s_lshl_b32 s5, s3, 7
    v_mov_b32 v72, s5
    ds_read_b32 v74, v72 offset:2304
    ds_read_b32 v75, v72 offset:2428
    s_lshl_b32 s5, s3, 5
    v_bfe_u32 v73, v0, 5, 1
    v_lshl_add_u32 v73, v73, 2, s5
    ds_read2_b32 v[236:237], v73 offset0:0 offset1:2
    ds_read_b32 v238, v73 offset:16
    s_mov_b32 s6, 0x07060302
    s_waitcnt lgkmcnt(0)
    s_mov_b64 exec, s[56:57]
    v_cmp_eq_u16 vcc, v220, v97
    v_perm_b32 v161, v161, v96, s6
    v_add_u32 v208, v96, v220
    v_lshrrev_b32 v97, 16, v97
    v_cndmask_b32 v208, v208, v97, vcc
    v_lshlrev_b16 v208, 4, v208
    ds_write_b128 v208, v[160:163] offset:30720
    s_mov_b64 exec, s[60:61]
    v_cmp_eq_u16 vcc, v222, v101
    v_perm_b32 v169, v169, v100, s6
    v_add_u32 v210, v100, v222
    v_lshrrev_b32 v101, 16, v101
    v_cndmask_b32 v210, v210, v101, vcc
    v_lshlrev_b16 v210, 4, v210
    ds_write_b128 v210, v[168:171] offset:30720
    s_mov_b64 exec, s[64:65]
    v_cmp_eq_u16 vcc, v224, v105
    v_perm_b32 v177, v177, v104, s6
    v_add_u32 v212, v104, v224
    v_lshrrev_b32 v105, 16, v105
    v_cndmask_b32 v212, v212, v105, vcc
    v_lshlrev_b16 v212, 4, v212
    ds_write_b128 v212, v[176:179] offset:30720
    s_mov_b64 exec, s[68:69]
    v_cmp_eq_u16 vcc, v226, v109
    v_perm_b32 v185, v185, v108, s6
    v_add_u32 v214, v108, v226
    v_lshrrev_b32 v109, 16, v109
    v_cndmask_b32 v214, v214, v109, vcc
    v_lshlrev_b16 v214, 4, v214
    ds_write_b128 v214, v[184:187] offset:30720
    s_mov_b64 exec, s[72:73]
    v_cmp_eq_u16 vcc, v228, v113
    v_perm_b32 v193, v193, v112, s6
    v_add_u32 v216, v112, v228
    v_lshrrev_b32 v113, 16, v113
    v_cndmask_b32 v216, v216, v113, vcc
    v_lshlrev_b16 v216, 4, v216
    ds_write_b128 v216, v[192:195] offset:30720
    s_cmp_eq_u32 s15, 0
    s_cbranch_scc1 K2_SZ
    s_mov_b64 exec, s[58:59]
    v_cmp_eq_u16 vcc, v221, v99
    v_perm_b32 v165, v165, v98, s6
    v_add_u32 v209, v98, v221
    v_lshrrev_b32 v99, 16, v99
    v_cndmask_b32 v209, v209, v99, vcc
    v_lshlrev_b16 v209, 4, v209
    ds_write_b128 v209, v[164:167] offset:30720
    s_mov_b64 exec, s[62:63]
    v_cmp_eq_u16 vcc, v223, v103
    v_perm_b32 v173, v173, v102, s6
    v_add_u32 v211, v102, v223
    v_lshrrev_b32 v103, 16, v103
    v_cndmask_b32 v211, v211, v103, vcc
    v_lshlrev_b16 v211, 4, v211
    ds_write_b128 v211, v[172:175] offset:30720
    s_mov_b64 exec, s[66:67]
    v_cmp_eq_u16 vcc, v225, v107
    v_perm_b32 v181, v181, v106, s6
    v_add_u32 v213, v106, v225
    v_lshrrev_b32 v107, 16, v107
    v_cndmask_b32 v213, v213, v107, vcc
    v_lshlrev_b16 v213, 4, v213
    ds_write_b128 v213, v[180:183] offset:30720
    s_mov_b64 exec, s[70:71]
    v_cmp_eq_u16 vcc, v227, v111
    v_perm_b32 v189, v189, v110, s6
    v_add_u32 v215, v110, v227
    v_lshrrev_b32 v111, 16, v111
    v_cndmask_b32 v215, v215, v111, vcc
    v_lshlrev_b16 v215, 4, v215
    ds_write_b128 v215, v[188:191] offset:30720
    s_mov_b64 exec, s[74:75]
    v_cmp_eq_u16 vcc, v229, v115
    v_perm_b32 v197, v197, v114, s6
    v_add_u32 v217, v114, v229
    v_lshrrev_b32 v115, 16, v115
    v_cndmask_b32 v217, v217, v115, vcc
    v_lshlrev_b16 v217, 4, v217
    ds_write_b128 v217, v[196:199] offset:30720
K2_SZ:
    s_mov_b64 exec, -1
    v_readfirstlane_b32 s13, v74
    v_readfirstlane_b32 s14, v75
    s_nop 0
    s_sub_u32 s14, s14, s13
    s_lshr_b32 s14, s14, 1
    s_lshl_b32 s13, s13, 4
    s_add_u32 s5, s13, -54272
    v_add_u32 v3, s5, v5
    s_add_u32 s5, s13, 30720
    v_add_u32 v4, s5, v4
    s_waitcnt vmcnt(2) lgkmcnt(0)
    s_barrier
    s_cmp_eq_u32 s14, 0
    s_cbranch_scc1 K2_DONE0
    ds_read_b128 v[48:51], v3 offset:0
    ds_read_b128 v[52:55], v3 offset:32
    ds_read_b128 v[56:59], v3 offset:64
    ds_read_b128 v[60:63], v3 offset:96
    ds_read_b128 v[64:67], v3 offset:128
    ds_read_b128 v[68:71], v3 offset:160
    ds_read_b128 v[72:75], v3 offset:192
    ds_read_b32 v12, v4
    v_add_u32 v8, 150528, v6
    s_waitcnt lgkmcnt(7)
    v_add_u32 v51, v51, v2
    buffer_load_dwordx4 v[88:91], v51, s[40:43], 0 idxen
    buffer_load_dword v80, v51, s[52:55], 0 idxen
    s_waitcnt lgkmcnt(6)
    v_add_u32 v55, v55, v2
    buffer_load_dwordx4 v[92:95], v55, s[40:43], 0 idxen
    buffer_load_dword v81, v55, s[52:55], 0 idxen
    s_waitcnt lgkmcnt(5)
    v_add_u32 v59, v59, v2
    buffer_load_dwordx4 v[96:99], v59, s[40:43], 0 idxen
    buffer_load_dword v82, v59, s[52:55], 0 idxen
    s_waitcnt lgkmcnt(4)
    v_add_u32 v63, v63, v2
    buffer_load_dwordx4 v[100:103], v63, s[40:43], 0 idxen
    buffer_load_dword v83, v63, s[52:55], 0 idxen
    s_waitcnt lgkmcnt(3)
    v_add_u32 v67, v67, v2
    buffer_load_dwordx4 v[104:107], v67, s[40:43], 0 idxen
    buffer_load_dword v84, v67, s[52:55], 0 idxen
    s_waitcnt lgkmcnt(0)
    v_mad_u32_u16 v12, v12, 32, v5
    ds_read_b128 v[20:23], v12
    ds_read_b128 v[32:35], v8 offset:0
    ds_read_b128 v[36:39], v8 offset:1024
    ds_read_b128 v[40:43], v8 offset:2048
    ds_read_b128 v[44:47], v8 offset:3072
    ds_read_b128 v[24:27], v8 offset:4096
    ds_read_b128 v[28:31], v8 offset:5120
    s_cmp_lg_u32 s11, 0
    s_cbranch_scc1 K2_R8
    s_mul_i32 s5, s3, 3072
    s_add_u32 s5, s5, 6144
    v_and_b32 v236, 0xfc, v236
    v_lshl_add_u32 v236, v236, 15, v1
    s_mov_b32 m0, s5
    s_add_u32 s5, s5, 1024
    buffer_load_dwordx4 v236, s[44:47], s7 offen lds
    v_and_b32 v237, 0xfc, v237
    v_lshl_add_u32 v237, v237, 15, v1
    s_mov_b32 m0, s5
    s_add_u32 s5, s5, 1024
    buffer_load_dwordx4 v237, s[44:47], s7 offen lds
    v_and_b32 v238, 0xfc, v238
    v_lshl_add_u32 v238, v238, 15, v1
    s_mov_b32 m0, s5
    s_add_u32 s5, s5, 1024
    buffer_load_dwordx4 v238, s[44:47], s7 offen lds
K2_R8:
    s_waitcnt lgkmcnt(0)
    s_setprio 3
    s_lshr_b32 s27, s3, 2
    s_mul_i32 s27, s27, 16
K2_BATCH:
    s_add_u32 s5, s14, s27
    s_lshr_b32 s5, s5, 5
    s_cmp_eq_u32 s5, 0
    s_cbranch_scc0 K2_PR0
    s_setprio 0
K2_PR0:
    s_cmp_eq_u32 s5, 1
    s_cbranch_scc0 K2_PR1
    s_setprio 1
K2_PR1:
    s_cmp_eq_u32 s5, 2
    s_cbranch_scc0 K2_PR2
    s_setprio 2
K2_PR2:
    v_mfma_f32_32x32x16_bf16 v[240:255], v[20:23], v[28:31], 0
    v_mfma_f32_32x32x16_bf16 v[224:239], v[20:23], v[24:27], 0
    v_mfma_f32_32x32x16_bf16 v[208:223], v[20:23], v[44:47], 0
    v_mfma_f32_32x32x16_bf16 v[176:191], v[20:23], v[36:39], 0
    v_mfma_f32_32x32x16_bf16 v[192:207], v[20:23], v[40:43], 0
    v_mfma_f32_32x32x16_bf16 v[160:175], v[20:23], v[32:35], 0
    s_waitcnt vmcnt(8) lgkmcnt(1)
    v_readfirstlane_b32 s26, v49
    v_add_u32 v71, v71, v2
    buffer_load_dwordx4 v[108:111], v71, s[40:43], 0 idxen
    buffer_load_dword v85, v71, s[52:55], 0 idxen
    ds_read_b128 v[76:79], v3 offset:224
    v_lshlrev_b32 v18, 16, v80
    v_mul_f32 v19, v80, v240
    v_lshlrev_b64 v[14:15], 16, v[88:89]
    v_lshlrev_b64 v[16:17], 16, v[90:91]
    v_mul_f32 v18, v18, v224
    s_set_gpr_idx_on s26, gpr_idx(SRC2,DST)
    v_pk_fma_f32 v[122:123], v[88:89], v[208:209], v[122:123] op_sel:[0,0,0] op_sel_hi:[1,0,1]
    v_fmac_f32 v125, v91, v208
    v_fmac_f32 v127, v90, v176
    v_pk_fma_f32 v[120:121], v[14:15], v[192:193], v[120:121] op_sel:[0,0,0] op_sel_hi:[1,0,1]
    v_fmac_f32 v124, v17, v192
    v_fmac_f32 v126, v16, v160
    v_pk_fma_f32 v[122:123], v[48:49], v[18:19], v[122:123] op_sel:[0,1,0] op_sel_hi:[1,1,1]
    v_pk_fma_f32 v[120:121], v[48:49], v[18:19], v[120:121] op_sel:[0,0,0] op_sel_hi:[1,0,1]
    v_pk_fma_f32 v[124:125], v[18:19], v[50:51], v[124:125] op_sel:[0,0,0] op_sel_hi:[1,0,1]
    s_set_gpr_idx_off
    s_waitcnt vmcnt(8) lgkmcnt(1)
    v_readfirstlane_b32 s26, v53
    v_add_u32 v75, v75, v2
    buffer_load_dwordx4 v[112:115], v75, s[40:43], 0 idxen
    buffer_load_dword v86, v75, s[52:55], 0 idxen
    ds_read_b128 v[48:51], v3 offset:256
    v_lshlrev_b32 v18, 16, v81
    v_mul_f32 v19, v81, v241
    v_lshlrev_b64 v[14:15], 16, v[92:93]
    v_lshlrev_b64 v[16:17], 16, v[94:95]
    v_mul_f32 v18, v18, v225
    s_set_gpr_idx_on s26, gpr_idx(SRC2,DST)
    v_pk_fma_f32 v[122:123], v[92:93], v[208:209], v[122:123] op_sel:[0,1,0] op_sel_hi:[1,1,1]
    v_fmac_f32 v125, v95, v209
    v_fmac_f32 v127, v94, v177
    v_pk_fma_f32 v[120:121], v[14:15], v[192:193], v[120:121] op_sel:[0,1,0] op_sel_hi:[1,1,1]
    v_fmac_f32 v124, v17, v193
    v_fmac_f32 v126, v16, v161
    v_pk_fma_f32 v[122:123], v[52:53], v[18:19], v[122:123] op_sel:[0,1,0] op_sel_hi:[1,1,1]
    v_pk_fma_f32 v[120:121], v[52:53], v[18:19], v[120:121] op_sel:[0,0,0] op_sel_hi:[1,0,1]
    v_pk_fma_f32 v[124:125], v[18:19], v[54:55], v[124:125] op_sel:[0,0,0] op_sel_hi:[1,0,1]
    s_set_gpr_idx_off
    s_waitcnt vmcnt(8) lgkmcnt(1)
    v_readfirstlane_b32 s26, v57
    v_add_u32 v79, v79, v2
    buffer_load_dwordx4 v[116:119], v79, s[40:43], 0 idxen
    buffer_load_dword v87, v79, s[52:55], 0 idxen
    ds_read_b32 v12, v4 offset:512
    ds_read_b128 v[52:55], v3 offset:288
    v_lshlrev_b32 v18, 16, v82
    v_mul_f32 v19, v82, v242
    v_lshlrev_b64 v[14:15], 16, v[96:97]
    v_lshlrev_b64 v[16:17], 16, v[98:99]
    v_mul_f32 v18, v18, v226
    s_set_gpr_idx_on s26, gpr_idx(SRC2,DST)
    v_pk_fma_f32 v[122:123], v[96:97], v[210:211], v[122:123] op_sel:[0,0,0] op_sel_hi:[1,0,1]
    v_fmac_f32 v125, v99, v210
    v_fmac_f32 v127, v98, v178
    v_pk_fma_f32 v[120:121], v[14:15], v[194:195], v[120:121] op_sel:[0,0,0] op_sel_hi:[1,0,1]
    v_fmac_f32 v124, v17, v194
    v_fmac_f32 v126, v16, v162
    v_pk_fma_f32 v[122:123], v[56:57], v[18:19], v[122:123] op_sel:[0,1,0] op_sel_hi:[1,1,1]
    v_pk_fma_f32 v[120:121], v[56:57], v[18:19], v[120:121] op_sel:[0,0,0] op_sel_hi:[1,0,1]
    v_pk_fma_f32 v[124:125], v[18:19], v[58:59], v[124:125] op_sel:[0,0,0] op_sel_hi:[1,0,1]
    s_set_gpr_idx_off
    s_waitcnt vmcnt(8) lgkmcnt(1)
    v_readfirstlane_b32 s26, v61
    v_add_u32 v51, v51, v2
    buffer_load_dwordx4 v[88:91], v51, s[40:43], 0 idxen
    buffer_load_dword v80, v51, s[52:55], 0 idxen
    ds_read_b128 v[56:59], v3 offset:320
    v_lshlrev_b32 v18, 16, v83
    v_mul_f32 v19, v83, v243
    v_lshlrev_b64 v[14:15], 16, v[100:101]
    v_lshlrev_b64 v[16:17], 16, v[102:103]
    v_mul_f32 v18, v18, v227
    s_set_gpr_idx_on s26, gpr_idx(SRC2,DST)
    v_pk_fma_f32 v[122:123], v[100:101], v[210:211], v[122:123] op_sel:[0,1,0] op_sel_hi:[1,1,1]
    v_fmac_f32 v125, v103, v211
    v_fmac_f32 v127, v102, v179
    v_pk_fma_f32 v[120:121], v[14:15], v[194:195], v[120:121] op_sel:[0,1,0] op_sel_hi:[1,1,1]
    v_fmac_f32 v124, v17, v195
    v_fmac_f32 v126, v16, v163
    v_pk_fma_f32 v[122:123], v[60:61], v[18:19], v[122:123] op_sel:[0,1,0] op_sel_hi:[1,1,1]
    v_pk_fma_f32 v[120:121], v[60:61], v[18:19], v[120:121] op_sel:[0,0,0] op_sel_hi:[1,0,1]
    v_pk_fma_f32 v[124:125], v[18:19], v[62:63], v[124:125] op_sel:[0,0,0] op_sel_hi:[1,0,1]
    s_set_gpr_idx_off
    s_cmp_le_i32 s14, 4
    s_cbranch_scc1 K2_DONE
    s_waitcnt vmcnt(8) lgkmcnt(1)
    v_readfirstlane_b32 s26, v65
    v_add_u32 v55, v55, v2
    buffer_load_dwordx4 v[92:95], v55, s[40:43], 0 idxen
    buffer_load_dword v81, v55, s[52:55], 0 idxen
    ds_read_b128 v[60:63], v3 offset:352
    v_lshlrev_b32 v18, 16, v84
    v_mul_f32 v19, v84, v244
    v_lshlrev_b64 v[14:15], 16, v[104:105]
    v_lshlrev_b64 v[16:17], 16, v[106:107]
    v_mul_f32 v18, v18, v228
    s_set_gpr_idx_on s26, gpr_idx(SRC2,DST)
    v_pk_fma_f32 v[122:123], v[104:105], v[212:213], v[122:123] op_sel:[0,0,0] op_sel_hi:[1,0,1]
    v_fmac_f32 v125, v107, v212
    v_fmac_f32 v127, v106, v180
    v_pk_fma_f32 v[120:121], v[14:15], v[196:197], v[120:121] op_sel:[0,0,0] op_sel_hi:[1,0,1]
    v_fmac_f32 v124, v17, v196
    v_fmac_f32 v126, v16, v164
    v_pk_fma_f32 v[122:123], v[64:65], v[18:19], v[122:123] op_sel:[0,1,0] op_sel_hi:[1,1,1]
    v_pk_fma_f32 v[120:121], v[64:65], v[18:19], v[120:121] op_sel:[0,0,0] op_sel_hi:[1,0,1]
    v_pk_fma_f32 v[124:125], v[18:19], v[66:67], v[124:125] op_sel:[0,0,0] op_sel_hi:[1,0,1]
    s_set_gpr_idx_off
    s_waitcnt vmcnt(8) lgkmcnt(1)
    v_readfirstlane_b32 s26, v69
    v_add_u32 v59, v59, v2
    buffer_load_dwordx4 v[96:99], v59, s[40:43], 0 idxen
    buffer_load_dword v82, v59, s[52:55], 0 idxen
    v_mad_u32_u16 v12, v12, 32, v5
    v_add_u32 v4, 512, v4
    ds_read_b128 v[20:23], v12
    ds_read_b128 v[64:67], v3 offset:384
    v_lshlrev_b32 v18, 16, v85
    v_mul_f32 v19, v85, v245
    v_lshlrev_b64 v[14:15], 16, v[108:109]
    v_lshlrev_b64 v[16:17], 16, v[110:111]
    v_mul_f32 v18, v18, v229
    s_set_gpr_idx_on s26, gpr_idx(SRC2,DST)
    v_pk_fma_f32 v[122:123], v[108:109], v[212:213], v[122:123] op_sel:[0,1,0] op_sel_hi:[1,1,1]
    v_fmac_f32 v125, v111, v213
    v_fmac_f32 v127, v110, v181
    v_pk_fma_f32 v[120:121], v[14:15], v[196:197], v[120:121] op_sel:[0,1,0] op_sel_hi:[1,1,1]
    v_fmac_f32 v124, v17, v197
    v_fmac_f32 v126, v16, v165
    v_pk_fma_f32 v[122:123], v[68:69], v[18:19], v[122:123] op_sel:[0,1,0] op_sel_hi:[1,1,1]
    v_pk_fma_f32 v[120:121], v[68:69], v[18:19], v[120:121] op_sel:[0,0,0] op_sel_hi:[1,0,1]
    v_pk_fma_f32 v[124:125], v[18:19], v[70:71], v[124:125] op_sel:[0,0,0] op_sel_hi:[1,0,1]
    s_set_gpr_idx_off
    s_waitcnt vmcnt(8) lgkmcnt(1)
    v_readfirstlane_b32 s26, v73
    v_add_u32 v63, v63, v2
    buffer_load_dwordx4 v[100:103], v63, s[40:43], 0 idxen
    buffer_load_dword v83, v63, s[52:55], 0 idxen
    ds_read_b128 v[68:71], v3 offset:416
    v_lshlrev_b32 v18, 16, v86
    v_mul_f32 v19, v86, v246
    v_lshlrev_b64 v[14:15], 16, v[112:113]
    v_lshlrev_b64 v[16:17], 16, v[114:115]
    v_mul_f32 v18, v18, v230
    s_set_gpr_idx_on s26, gpr_idx(SRC2,DST)
    v_pk_fma_f32 v[122:123], v[112:113], v[214:215], v[122:123] op_sel:[0,0,0] op_sel_hi:[1,0,1]
    v_fmac_f32 v125, v115, v214
    v_fmac_f32 v127, v114, v182
    v_pk_fma_f32 v[120:121], v[14:15], v[198:199], v[120:121] op_sel:[0,0,0] op_sel_hi:[1,0,1]
    v_fmac_f32 v124, v17, v198
    v_fmac_f32 v126, v16, v166
    v_pk_fma_f32 v[122:123], v[72:73], v[18:19], v[122:123] op_sel:[0,1,0] op_sel_hi:[1,1,1]
    v_pk_fma_f32 v[120:121], v[72:73], v[18:19], v[120:121] op_sel:[0,0,0] op_sel_hi:[1,0,1]
    v_pk_fma_f32 v[124:125], v[18:19], v[74:75], v[124:125] op_sel:[0,0,0] op_sel_hi:[1,0,1]
    s_set_gpr_idx_off
    s_waitcnt vmcnt(8) lgkmcnt(1)
    v_readfirstlane_b32 s26, v77
    v_add_u32 v67, v67, v2
    buffer_load_dwordx4 v[104:107], v67, s[40:43], 0 idxen
    buffer_load_dword v84, v67, s[52:55], 0 idxen
    ds_read_b128 v[72:75], v3 offset:448
    v_lshlrev_b32 v18, 16, v87
    v_mul_f32 v19, v87, v247
    v_lshlrev_b64 v[14:15], 16, v[116:117]
    v_lshlrev_b64 v[16:17], 16, v[118:119]
    v_mul_f32 v18, v18, v231
    s_set_gpr_idx_on s26, gpr_idx(SRC2,DST)
    v_pk_fma_f32 v[122:123], v[116:117], v[214:215], v[122:123] op_sel:[0,1,0] op_sel_hi:[1,1,1]
    v_fmac_f32 v125, v119, v215
    v_fmac_f32 v127, v118, v183
    v_pk_fma_f32 v[120:121], v[14:15], v[198:199], v[120:121] op_sel:[0,1,0] op_sel_hi:[1,1,1]
    v_fmac_f32 v124, v17, v199
    v_fmac_f32 v126, v16, v167
    v_pk_fma_f32 v[122:123], v[76:77], v[18:19], v[122:123] op_sel:[0,1,0] op_sel_hi:[1,1,1]
    v_pk_fma_f32 v[120:121], v[76:77], v[18:19], v[120:121] op_sel:[0,0,0] op_sel_hi:[1,0,1]
    v_pk_fma_f32 v[124:125], v[18:19], v[78:79], v[124:125] op_sel:[0,0,0] op_sel_hi:[1,0,1]
    s_set_gpr_idx_off
    s_cmp_le_i32 s14, 8
    s_cbranch_scc1 K2_DONE
    s_waitcnt vmcnt(8) lgkmcnt(1)
    v_readfirstlane_b32 s26, v49
    v_add_u32 v71, v71, v2
    buffer_load_dwordx4 v[108:111], v71, s[40:43], 0 idxen
    buffer_load_dword v85, v71, s[52:55], 0 idxen
    ds_read_b128 v[76:79], v3 offset:480
    v_lshlrev_b32 v18, 16, v80
    v_mul_f32 v19, v80, v248
    v_lshlrev_b64 v[14:15], 16, v[88:89]
    v_lshlrev_b64 v[16:17], 16, v[90:91]
    v_mul_f32 v18, v18, v232
    s_set_gpr_idx_on s26, gpr_idx(SRC2,DST)
    v_pk_fma_f32 v[122:123], v[88:89], v[216:217], v[122:123] op_sel:[0,0,0] op_sel_hi:[1,0,1]
    v_fmac_f32 v125, v91, v216
    v_fmac_f32 v127, v90, v184
    v_pk_fma_f32 v[120:121], v[14:15], v[200:201], v[120:121] op_sel:[0,0,0] op_sel_hi:[1,0,1]
    v_fmac_f32 v124, v17, v200
    v_fmac_f32 v126, v16, v168
    v_pk_fma_f32 v[122:123], v[48:49], v[18:19], v[122:123] op_sel:[0,1,0] op_sel_hi:[1,1,1]
    v_pk_fma_f32 v[120:121], v[48:49], v[18:19], v[120:121] op_sel:[0,0,0] op_sel_hi:[1,0,1]
    v_pk_fma_f32 v[124:125], v[18:19], v[50:51], v[124:125] op_sel:[0,0,0] op_sel_hi:[1,0,1]
    s_set_gpr_idx_off
    s_waitcnt vmcnt(8) lgkmcnt(1)
    v_readfirstlane_b32 s26, v53
    v_add_u32 v75, v75, v2
    buffer_load_dwordx4 v[112:115], v75, s[40:43], 0 idxen
    buffer_load_dword v86, v75, s[52:55], 0 idxen
    ds_read_b128 v[48:51], v3 offset:512
    v_lshlrev_b32 v18, 16, v81
    v_mul_f32 v19, v81, v249
    v_lshlrev_b64 v[14:15], 16, v[92:93]
    v_lshlrev_b64 v[16:17], 16, v[94:95]
    v_mul_f32 v18, v18, v233
    s_set_gpr_idx_on s26, gpr_idx(SRC2,DST)
    v_pk_fma_f32 v[122:123], v[92:93], v[216:217], v[122:123] op_sel:[0,1,0] op_sel_hi:[1,1,1]
    v_fmac_f32 v125, v95, v217
    v_fmac_f32 v127, v94, v185
    v_pk_fma_f32 v[120:121], v[14:15], v[200:201], v[120:121] op_sel:[0,1,0] op_sel_hi:[1,1,1]
    v_fmac_f32 v124, v17, v201
    v_fmac_f32 v126, v16, v169
    v_pk_fma_f32 v[122:123], v[52:53], v[18:19], v[122:123] op_sel:[0,1,0] op_sel_hi:[1,1,1]
    v_pk_fma_f32 v[120:121], v[52:53], v[18:19], v[120:121] op_sel:[0,0,0] op_sel_hi:[1,0,1]
    v_pk_fma_f32 v[124:125], v[18:19], v[54:55], v[124:125] op_sel:[0,0,0] op_sel_hi:[1,0,1]
    s_set_gpr_idx_off
    s_waitcnt vmcnt(8) lgkmcnt(1)
    v_readfirstlane_b32 s26, v57
    v_add_u32 v79, v79, v2
    buffer_load_dwordx4 v[116:119], v79, s[40:43], 0 idxen
    buffer_load_dword v87, v79, s[52:55], 0 idxen
    ds_read_b128 v[52:55], v3 offset:544
    v_lshlrev_b32 v18, 16, v82
    v_mul_f32 v19, v82, v250
    v_lshlrev_b64 v[14:15], 16, v[96:97]
    v_lshlrev_b64 v[16:17], 16, v[98:99]
    v_mul_f32 v18, v18, v234
    s_set_gpr_idx_on s26, gpr_idx(SRC2,DST)
    v_pk_fma_f32 v[122:123], v[96:97], v[218:219], v[122:123] op_sel:[0,0,0] op_sel_hi:[1,0,1]
    v_fmac_f32 v125, v99, v218
    v_fmac_f32 v127, v98, v186
    v_pk_fma_f32 v[120:121], v[14:15], v[202:203], v[120:121] op_sel:[0,0,0] op_sel_hi:[1,0,1]
    v_fmac_f32 v124, v17, v202
    v_fmac_f32 v126, v16, v170
    v_pk_fma_f32 v[122:123], v[56:57], v[18:19], v[122:123] op_sel:[0,1,0] op_sel_hi:[1,1,1]
    v_pk_fma_f32 v[120:121], v[56:57], v[18:19], v[120:121] op_sel:[0,0,0] op_sel_hi:[1,0,1]
    v_pk_fma_f32 v[124:125], v[18:19], v[58:59], v[124:125] op_sel:[0,0,0] op_sel_hi:[1,0,1]
    s_set_gpr_idx_off
    s_waitcnt vmcnt(8) lgkmcnt(1)
    v_readfirstlane_b32 s26, v61
    v_add_u32 v51, v51, v2
    buffer_load_dwordx4 v[88:91], v51, s[40:43], 0 idxen
    buffer_load_dword v80, v51, s[52:55], 0 idxen
    ds_read_b128 v[56:59], v3 offset:576
    v_lshlrev_b32 v18, 16, v83
    v_mul_f32 v19, v83, v251
    v_lshlrev_b64 v[14:15], 16, v[100:101]
    v_lshlrev_b64 v[16:17], 16, v[102:103]
    v_mul_f32 v18, v18, v235
    s_set_gpr_idx_on s26, gpr_idx(SRC2,DST)
    v_pk_fma_f32 v[122:123], v[100:101], v[218:219], v[122:123] op_sel:[0,1,0] op_sel_hi:[1,1,1]
    v_fmac_f32 v125, v103, v219
    v_fmac_f32 v127, v102, v187
    v_pk_fma_f32 v[120:121], v[14:15], v[202:203], v[120:121] op_sel:[0,1,0] op_sel_hi:[1,1,1]
    v_fmac_f32 v124, v17, v203
    v_fmac_f32 v126, v16, v171
    v_pk_fma_f32 v[122:123], v[60:61], v[18:19], v[122:123] op_sel:[0,1,0] op_sel_hi:[1,1,1]
    v_pk_fma_f32 v[120:121], v[60:61], v[18:19], v[120:121] op_sel:[0,0,0] op_sel_hi:[1,0,1]
    v_pk_fma_f32 v[124:125], v[18:19], v[62:63], v[124:125] op_sel:[0,0,0] op_sel_hi:[1,0,1]
    s_set_gpr_idx_off
    s_cmp_le_i32 s14, 12
    s_cbranch_scc1 K2_DONE
    s_waitcnt vmcnt(8) lgkmcnt(1)
    v_readfirstlane_b32 s26, v65
    v_add_u32 v55, v55, v2
    buffer_load_dwordx4 v[92:95], v55, s[40:43], 0 idxen
    buffer_load_dword v81, v55, s[52:55], 0 idxen
    ds_read_b128 v[60:63], v3 offset:608
    v_lshlrev_b32 v18, 16, v84
    v_mul_f32 v19, v84, v252
    v_lshlrev_b64 v[14:15], 16, v[104:105]
    v_lshlrev_b64 v[16:17], 16, v[106:107]
    v_mul_f32 v18, v18, v236
    s_set_gpr_idx_on s26, gpr_idx(SRC2,DST)
    v_pk_fma_f32 v[122:123], v[104:105], v[220:221], v[122:123] op_sel:[0,0,0] op_sel_hi:[1,0,1]
    v_fmac_f32 v125, v107, v220
    v_fmac_f32 v127, v106, v188
    v_pk_fma_f32 v[120:121], v[14:15], v[204:205], v[120:121] op_sel:[0,0,0] op_sel_hi:[1,0,1]
    v_fmac_f32 v124, v17, v204
    v_fmac_f32 v126, v16, v172
    v_pk_fma_f32 v[122:123], v[64:65], v[18:19], v[122:123] op_sel:[0,1,0] op_sel_hi:[1,1,1]
    v_pk_fma_f32 v[120:121], v[64:65], v[18:19], v[120:121] op_sel:[0,0,0] op_sel_hi:[1,0,1]
    v_pk_fma_f32 v[124:125], v[18:19], v[66:67], v[124:125] op_sel:[0,0,0] op_sel_hi:[1,0,1]
    s_set_gpr_idx_off
    s_waitcnt vmcnt(8) lgkmcnt(1)
    v_readfirstlane_b32 s26, v69
    v_add_u32 v59, v59, v2
    buffer_load_dwordx4 v[96:99], v59, s[40:43], 0 idxen
    buffer_load_dword v82, v59, s[52:55], 0 idxen
    ds_read_b128 v[64:67], v3 offset:640
    v_lshlrev_b32 v18, 16, v85
    v_mul_f32 v19, v85, v253
    v_lshlrev_b64 v[14:15], 16, v[108:109]
    v_lshlrev_b64 v[16:17], 16, v[110:111]
    v_mul_f32 v18, v18, v237
    s_set_gpr_idx_on s26, gpr_idx(SRC2,DST)
    v_pk_fma_f32 v[122:123], v[108:109], v[220:221], v[122:123] op_sel:[0,1,0] op_sel_hi:[1,1,1]
    v_fmac_f32 v125, v111, v221
    v_fmac_f32 v127, v110, v189
    v_pk_fma_f32 v[120:121], v[14:15], v[204:205], v[120:121] op_sel:[0,1,0] op_sel_hi:[1,1,1]
    v_fmac_f32 v124, v17, v205
    v_fmac_f32 v126, v16, v173
    v_pk_fma_f32 v[122:123], v[68:69], v[18:19], v[122:123] op_sel:[0,1,0] op_sel_hi:[1,1,1]
    v_pk_fma_f32 v[120:121], v[68:69], v[18:19], v[120:121] op_sel:[0,0,0] op_sel_hi:[1,0,1]
    v_pk_fma_f32 v[124:125], v[18:19], v[70:71], v[124:125] op_sel:[0,0,0] op_sel_hi:[1,0,1]
    s_set_gpr_idx_off
    s_waitcnt vmcnt(8) lgkmcnt(1)
    v_readfirstlane_b32 s26, v73
    v_add_u32 v63, v63, v2
    buffer_load_dwordx4 v[100:103], v63, s[40:43], 0 idxen
    buffer_load_dword v83, v63, s[52:55], 0 idxen
    ds_read_b128 v[68:71], v3 offset:672
    v_lshlrev_b32 v18, 16, v86
    v_mul_f32 v19, v86, v254
    v_lshlrev_b64 v[14:15], 16, v[112:113]
    v_lshlrev_b64 v[16:17], 16, v[114:115]
    v_mul_f32 v18, v18, v238
    s_set_gpr_idx_on s26, gpr_idx(SRC2,DST)
    v_pk_fma_f32 v[122:123], v[112:113], v[222:223], v[122:123] op_sel:[0,0,0] op_sel_hi:[1,0,1]
    v_fmac_f32 v125, v115, v222
    v_fmac_f32 v127, v114, v190
    v_pk_fma_f32 v[120:121], v[14:15], v[206:207], v[120:121] op_sel:[0,0,0] op_sel_hi:[1,0,1]
    v_fmac_f32 v124, v17, v206
    v_fmac_f32 v126, v16, v174
    v_pk_fma_f32 v[122:123], v[72:73], v[18:19], v[122:123] op_sel:[0,1,0] op_sel_hi:[1,1,1]
    v_pk_fma_f32 v[120:121], v[72:73], v[18:19], v[120:121] op_sel:[0,0,0] op_sel_hi:[1,0,1]
    v_pk_fma_f32 v[124:125], v[18:19], v[74:75], v[124:125] op_sel:[0,0,0] op_sel_hi:[1,0,1]
    s_set_gpr_idx_off
    s_waitcnt vmcnt(8) lgkmcnt(1)
    v_readfirstlane_b32 s26, v77
    v_add_u32 v67, v67, v2
    buffer_load_dwordx4 v[104:107], v67, s[40:43], 0 idxen
    buffer_load_dword v84, v67, s[52:55], 0 idxen
    ds_read_b128 v[72:75], v3 offset:704
    v_lshlrev_b32 v18, 16, v87
    v_mul_f32 v19, v87, v255
    v_lshlrev_b64 v[14:15], 16, v[116:117]
    v_lshlrev_b64 v[16:17], 16, v[118:119]
    v_mul_f32 v18, v18, v239
    s_set_gpr_idx_on s26, gpr_idx(SRC2,DST)
    v_pk_fma_f32 v[122:123], v[116:117], v[222:223], v[122:123] op_sel:[0,1,0] op_sel_hi:[1,1,1]
    v_fmac_f32 v125, v119, v223
    v_fmac_f32 v127, v118, v191
    v_pk_fma_f32 v[120:121], v[14:15], v[206:207], v[120:121] op_sel:[0,1,0] op_sel_hi:[1,1,1]
    v_fmac_f32 v124, v17, v207
    v_fmac_f32 v126, v16, v175
    v_pk_fma_f32 v[122:123], v[76:77], v[18:19], v[122:123] op_sel:[0,1,0] op_sel_hi:[1,1,1]
    v_pk_fma_f32 v[120:121], v[76:77], v[18:19], v[120:121] op_sel:[0,0,0] op_sel_hi:[1,0,1]
    v_pk_fma_f32 v[124:125], v[18:19], v[78:79], v[124:125] op_sel:[0,0,0] op_sel_hi:[1,0,1]
    s_set_gpr_idx_off
    v_add_u32 v3, 512, v3
    s_sub_u32 s14, s14, 16
    s_cmp_gt_i32 s14, 0
    s_cbranch_scc1 K2_BATCH
K2_DONE:
    s_waitcnt vmcnt(8) lgkmcnt(0)
    s_add_u32 s11, s11, s10
    s_cmp_ge_u32 s11, s8
    s_cbranch_scc1 K2_EPI
    s_waitcnt vmcnt(0)
    s_barrier
    v_lshrrev_b32 v60, 4, v0
    v_lshlrev_b32 v61, 2, v60
    s_branch K2_ROUND
K2_EPI:
    s_mul_i32 s5, s3, 3072
    v_lshl_add_u32 v8, v2, 2, s5
    v_and_b32 v9, 32, v0
    v_lshlrev_b32 v9, 3, v9
    v_add_u32 v12, v8, v9
    v_sub_u32 v13, v8, v9
    ds_read_b32 v56, v12 offset:6272
    ds_read_b32 v57, v13 offset:6400
    ds_read_b32 v58, v12 offset:6784
    ds_read_b32 v59, v13 offset:6912
    ds_read_b32 v60, v12 offset:7296
    ds_read_b32 v61, v13 offset:7424
    ds_read_b32 v62, v12 offset:7808
    ds_read_b32 v63, v13 offset:7936
    ds_read_b32 v64, v12 offset:8320
    ds_read_b32 v65, v13 offset:8448
    s_lshl_b32 s6, s3, 5
    v_lshrrev_b32 v9, 6, v9
    v_add_u32 v9, s6, v9
    ds_read2_b32 v[48:49], v9 offset0:0 offset1:2
    ds_read_b32 v50, v9 offset:16
    v_add_u32 v10, s5, v6
    v_permlane32_swap_b32 v120, v124
    v_permlane32_swap_b32 v121, v126
    v_permlane32_swap_b32 v122, v125
    v_permlane32_swap_b32 v123, v127
    v_add_f32 v120, v120, v124
    v_add_f32 v121, v121, v126
    v_add_f32 v122, v122, v125
    v_add_f32 v123, v123, v127
    s_waitcnt lgkmcnt(0)
    v_lshlrev_b32 v124, 16, v56
    v_lshlrev_b32 v125, 16, v57
    v_and_b32 v126, 0xffff0000, v56
    v_and_b32 v127, 0xffff0000, v57
    v_pk_add_f32 v[120:121], v[120:121], v[124:125]
    v_pk_add_f32 v[122:123], v[122:123], v[126:127]
    v_cvt_pk_bf16_f32 v124, v120, v122
    v_cvt_pk_bf16_f32 v125, v121, v123
    ds_write_b32 v12, v124 offset:6272
    ds_write_b32 v13, v125 offset:6400
    v_permlane32_swap_b32 v128, v132
    v_permlane32_swap_b32 v129, v134
    v_permlane32_swap_b32 v130, v133
    v_permlane32_swap_b32 v131, v135
    v_add_f32 v128, v128, v132
    v_add_f32 v129, v129, v134
    v_add_f32 v130, v130, v133
    v_add_f32 v131, v131, v135
    v_lshlrev_b32 v132, 16, v58
    v_lshlrev_b32 v133, 16, v59
    v_and_b32 v134, 0xffff0000, v58
    v_and_b32 v135, 0xffff0000, v59
    v_pk_add_f32 v[128:129], v[128:129], v[132:133]
    v_pk_add_f32 v[130:131], v[130:131], v[134:135]
    v_cvt_pk_bf16_f32 v132, v128, v130
    v_cvt_pk_bf16_f32 v133, v129, v131
    ds_write_b32 v12, v132 offset:6784
    ds_write_b32 v13, v133 offset:6912
    ds_read_b128 v[68:71], v10 offset:6144
    v_lshl_add_u32 v48, v48, 15, v1
    v_permlane32_swap_b32 v136, v140
    v_permlane32_swap_b32 v137, v142
    v_permlane32_swap_b32 v138, v141
    v_permlane32_swap_b32 v139, v143
    v_add_f32 v136, v136, v140
    v_add_f32 v137, v137, v142
    v_add_f32 v138, v138, v141
    v_add_f32 v139, v139, v143
    v_lshlrev_b32 v140, 16, v60
    v_lshlrev_b32 v141, 16, v61
    v_and_b32 v142, 0xffff0000, v60
    v_and_b32 v143, 0xffff0000, v61
    v_pk_add_f32 v[136:137], v[136:137], v[140:141]
    v_pk_add_f32 v[138:139], v[138:139], v[142:143]
    v_cvt_pk_bf16_f32 v140, v136, v138
    v_cvt_pk_bf16_f32 v141, v137, v139
    ds_write_b32 v12, v140 offset:7296
    ds_write_b32 v13, v141 offset:7424
    v_permlane32_swap_b32 v144, v148
    v_permlane32_swap_b32 v145, v150
    v_permlane32_swap_b32 v146, v149
    v_permlane32_swap_b32 v147, v151
    v_add_f32 v144, v144, v148
    v_add_f32 v145, v145, v150
    v_add_f32 v146, v146, v149
    v_add_f32 v147, v147, v151
    v_lshlrev_b32 v148, 16, v62
    v_lshlrev_b32 v149, 16, v63
    v_and_b32 v150, 0xffff0000, v62
    v_and_b32 v151, 0xffff0000, v63
    v_pk_add_f32 v[144:145], v[144:145], v[148:149]
    v_pk_add_f32 v[146:147], v[146:147], v[150:151]
    v_cvt_pk_bf16_f32 v148, v144, v146
    v_cvt_pk_bf16_f32 v149, v145, v147
    ds_write_b32 v12, v148 offset:7808
    ds_write_b32 v13, v149 offset:7936
    ds_read_b128 v[72:75], v10 offset:7168
    v_lshl_add_u32 v49, v49, 15, v1
    v_permlane32_swap_b32 v152, v156
    v_permlane32_swap_b32 v153, v158
    v_permlane32_swap_b32 v154, v157
    v_permlane32_swap_b32 v155, v159
    v_add_f32 v152, v152, v156
    v_add_f32 v153, v153, v158
    v_add_f32 v154, v154, v157
    v_add_f32 v155, v155, v159
    v_lshlrev_b32 v156, 16, v64
    v_lshlrev_b32 v157, 16, v65
    v_and_b32 v158, 0xffff0000, v64
    v_and_b32 v159, 0xffff0000, v65
    v_pk_add_f32 v[152:153], v[152:153], v[156:157]
    v_pk_add_f32 v[154:155], v[154:155], v[158:159]
    v_cvt_pk_bf16_f32 v156, v152, v154
    v_cvt_pk_bf16_f32 v157, v153, v155
    ds_write_b32 v12, v156 offset:8320
    ds_write_b32 v13, v157 offset:8448
    ds_read_b128 v[76:79], v10 offset:8192
    v_lshl_add_u32 v50, v50, 15, v1
    s_waitcnt lgkmcnt(8)
    buffer_store_dwordx4 v[68:71], v48, s[48:51], s7 offen sc1 nt
    s_waitcnt lgkmcnt(3)
    buffer_store_dwordx4 v[72:75], v49, s[48:51], s7 offen sc1 nt
    s_mov_b32 exec_hi, 0
    s_waitcnt lgkmcnt(0)
    buffer_store_dwordx4 v[76:79], v50, s[48:51], s7 offen sc1 nt
    s_mov_b64 exec, -1
K2_END:
    s_endpgm
K2_DONE0:
    s_cmp_lg_u32 s11, 0
    s_cbranch_scc1 K2_R8B
    s_mul_i32 s5, s3, 3072
    s_add_u32 s5, s5, 6144
    v_and_b32 v236, 0xfc, v236
    v_lshl_add_u32 v236, v236, 15, v1
    s_mov_b32 m0, s5
    s_add_u32 s5, s5, 1024
    buffer_load_dwordx4 v236, s[44:47], s7 offen lds
    v_and_b32 v237, 0xfc, v237
    v_lshl_add_u32 v237, v237, 15, v1
    s_mov_b32 m0, s5
    s_add_u32 s5, s5, 1024
    buffer_load_dwordx4 v237, s[44:47], s7 offen lds
    v_and_b32 v238, 0xfc, v238
    v_lshl_add_u32 v238, v238, 15, v1
    s_mov_b32 m0, s5
    s_add_u32 s5, s5, 1024
    buffer_load_dwordx4 v238, s[44:47], s7 offen lds
K2_R8B:
    s_waitcnt vmcnt(0)
    s_branch K2_DONE
.fill 64, 4, 0xbf800000
.section .rodata,"a"
.p2align 6
.amdhsa_kernel painn_prep_kernel
  .amdhsa_next_free_vgpr 128
  .amdhsa_next_free_sgpr 100
  .amdhsa_accum_offset 128
  .amdhsa_group_segment_fixed_size 0
  .amdhsa_kernarg_size 88
  .amdhsa_user_sgpr_count 2
  .amdhsa_user_sgpr_kernarg_segment_ptr 1
  .amdhsa_system_sgpr_workgroup_id_x 1
.end_amdhsa_kernel
.p2align 6
.amdhsa_kernel painn_msg_kernel
  .amdhsa_next_free_vgpr 256
  .amdhsa_next_free_sgpr 100
  .amdhsa_accum_offset 256
  .amdhsa_group_segment_fixed_size 0
  .amdhsa_kernarg_size 88
  .amdhsa_user_sgpr_count 2
  .amdhsa_user_sgpr_kernarg_segment_ptr 1
  .amdhsa_system_sgpr_workgroup_id_x 1
.end_amdhsa_kernel
```
